```python
import torch

def _softmax(x, axis=-1):
    return torch.softmax(x, dim=axis)
def _gelu(x):
    return torch.nn.functional.gelu(x, approximate="tanh")
def _silu(x):
    return torch.nn.functional.silu(x)
def _sigmoid(x):
    return torch.sigmoid(x)
def _layernorm(x, axis=-1, eps=1e-5):
    m = x.mean(dim=axis, keepdim=True)
    v = x.var(dim=axis, keepdim=True, unbiased=False)
    return (x - m) / torch.sqrt(v + eps)
def _scatter_add(tgt, idx, src, axis=0):
    return tgt.clone().index_add_(axis, idx, src)
def _segment_sum(src, seg, n):
    out = torch.zeros((n,) + src.shape[1:], dtype=src.dtype)
    return out.index_add_(0, seg, src)
def _pad(x, pw):
    flat = tuple(v for pair in reversed(pw) for v in pair)
    return torch.nn.functional.pad(x, flat)

kernel_name = 'parallel_sum__sliding_block__geglu_ffn__prompt'

def setup_inputs():

    _w = (lambda a: (lambda t: t.to(torch.bfloat16) if t.is_floating_point() else t)(torch.as_tensor(a)))
    def _A_setup():
        B, S, D = 1, 2048, 448
        return {
            "x": _w((lambda *s: torch.randn(*s, dtype=torch.bfloat16) * 0.05)(B, S, D)),
            "wqkv": _w((lambda *s: torch.randn(*s, dtype=torch.bfloat16) * 0.1)(D, 3 * D)),
            "wo": _w((lambda *s: torch.randn(*s, dtype=torch.bfloat16) * 0.05)(D, D)),
        }
    _A_in = _A_setup()

    def _B_setup():
        B, S, D, F = 1, 2048, 448, 1792
        return {
            "x": _w((lambda *s: torch.randn(*s, dtype=torch.bfloat16) * 0.05)(B, S, D)),
            "w_gate": _w((lambda *s: torch.randn(*s, dtype=torch.bfloat16) * 0.05)(D, F)),
            "w_up": _w((lambda *s: torch.randn(*s, dtype=torch.bfloat16) * 0.05)(D, F)),
            "w_down": _w((lambda *s: torch.randn(*s, dtype=torch.bfloat16) * 0.05)(F, D)),
        }
    _B_in = _B_setup()

    return {
        "A_x": _A_in["x"],
        "A_wqkv": _A_in["wqkv"],
        "A_wo": _A_in["wo"],
        "B_x": _B_in["x"],
        "B_w_gate": _B_in["w_gate"],
        "B_w_up": _B_in["w_up"],
        "B_w_down": _B_in["w_down"],
    }

def reference(A_x, A_wqkv, A_wo, B_x, B_w_gate, B_w_up, B_w_down):
    def _A_ref(x, wqkv, wo):
        B, S, D = x.shape
        H = 16; Dh = D // H; W = 256
        qkv = (lambda x, *d: x.permute(*d))((x @ wqkv).reshape(B, S, 3, H, Dh), 2, 0, 3, 1, 4)
        q, k, v = qkv[0], qkv[1], qkv[2]
        scores = torch.einsum("bhqd,bhkd->bhqk", q, k) * (Dh ** -0.5)
        idx = torch.arange(S)
        mask = (idx[:, None] - idx[None, :] >= 0) & (idx[:, None] - idx[None, :] < W)
        scores = torch.where(mask[None, None], scores, -1e9)
        p = _softmax(scores, axis=-1)
        o = torch.einsum("bhqk,bhkd->bhqd", p, v)
        return (lambda x, *d: x.permute(*d))(o, 0, 2, 1, 3).reshape(B, S, D) @ wo

    def _B_ref(x, w_gate, w_up, w_down):
        return (_gelu(x @ w_gate) * (x @ w_up)) @ w_down

    x = A_x
    xn = _layernorm(x, axis=-1)
    return x + _A_ref(xn, A_wqkv, A_wo) + _B_ref(xn, B_w_gate, B_w_up, B_w_down)
```

```asm
; @launch grid=(256,1,1) block=(256,1,1) lds=163840
.amdgcn_target "amdgcn-amd-amdhsa--gfx950"
.text
.globl parallel_sum__sliding_block__geglu_ffn__prompt_kernel
.type parallel_sum__sliding_block__geglu_ffn__prompt_kernel,@function
.p2align 8
parallel_sum__sliding_block__geglu_ffn__prompt_kernel:
  s_load_dwordx16 s[64:79], s[0:1], 0
  s_load_dwordx4 s[80:83], s[0:1], 64
  s_cmp_ge_u32 s2, 256
  s_cbranch_scc1 L_end
  s_getpc_b64 s[84:85]
L_pc:
  s_mov_b32 s86, L_codeend-L_pc
  s_mov_b32 s87, 0x20000
  v_lshlrev_b32_e64 v67, 7, v0
  s_bfe_u32 s4, s2, 0x30003
  s_lshl_b32 s57, s4, 12
  v_cmp_gt_u32_e64 vcc, 32, v0
  s_nop 0
  s_and_saveexec_b64 s[60:61], vcc
  s_cbranch_execz L_nopf
  buffer_load_dword v68, v67, s[84:87], s57 offen
L_nopf:
  s_mov_b64 exec, -1
  v_lshrrev_b32 v62, 6, v0
  v_and_b32 v1, 63, v0
  v_readfirstlane_b32 s3, v62
  s_and_b32 s57, s2, 1
  s_lshl3_add_u32 s4, s57, s4
  s_bfe_u32 s58, s2, 0x20001
  s_lshr_b32 s59, s2, 6
  s_lshl2_add_u32 s5, s58, s59
  s_mov_b32 s48, 0
  s_and_b32 s6, s3, 1
  s_lshr_b32 s7, s3, 1
  s_lshl_b32 s56, s3, 12
  v_lshrrev_b32 v62, 3, v1
  v_and_b32 v63, 7, v1
  v_lshrrev_b32 v64, 4, v1
  s_lshl2_add_u32 s57, s4, s3
  s_mul_i32 s57, s57, 28672
  v_mul_u32_u24 v65, 896, v62
  v_add_u32 v65, s57, v65
  v_xor_b32 v66, v63, v64
  v_lshl_add_u32 v2, v66, 4, v65
  v_xor_b32_e64 v66, 4, v66
  v_lshl_add_u32 v3, v66, 4, v65
  v_add_u32 v3, 6144, v3
  v_add_u32 v4, 12288, v2
  v_add_u32 v5, 12288, v3
  s_mul_i32 s60, s58, 3
  s_add_u32 s89, s60, s59
  s_lshl_b32 s62, s89, 1
  s_add_u32 s63, s62, 1
  s_lshl1_add_u32 s88, s58, 13
  s_add_u32 s93, s58, 12
  s_add_u32 s57, s58, 24
  s_add_u32 s60, s88, s7
  s_movk_i32 s55, 3584
  s_cmp_eq_u32 s59, 3
  s_cselect_b32 s61, 1, 0
  s_cselect_b32 s63, s57, s63
  s_cselect_b32 s89, s93, s89
  s_cselect_b32 s60, s60, s62
  s_cselect_b32 s55, 2688, s55
  s_lshl_b32 s60, s60, 7
  v_and_b32 v65, 1, v64
  v_lshlrev_b32 v65, 1, v65
  v_xor_b32 v65, v63, v65
  v_mul_u32_u24 v10, 2688, v62
  v_lshl_add_u32 v10, v65, 4, v10
  v_add_u32 v11, 20480, v10
  v_add_u32 v12, 40960, v10
  v_add_u32 v13, 61440, v10
  s_mul_i32 s91, s6, 86016
  s_lshl_b32 s59, s89, 7
  s_sub_u32 s22, 1204224, s59
  s_mov_b32 s23, 0x20000
  s_mov_b32 s10, 1835008
  s_mov_b32 s11, 0x20000
  s_add_u32 s49, s48, 1
  s_cmp_eq_u32 s49, 7
  s_cselect_b32 s49, 0, s49
  s_waitcnt lgkmcnt(0)
  s_mov_b32 s8, s64
  s_mov_b32 s9, s65
  s_add_u32 m0, s56, 0
  s_lshl_b32 s93, s48, 7
  buffer_load_dwordx4 v2, s[8:11], s93 offen offset:0 lds
  buffer_load_dwordx4 v3, s[8:11], s93 offen offset:1024 lds
  buffer_load_dwordx4 v4, s[8:11], s93 offen offset:2048 lds
  buffer_load_dwordx4 v5, s[8:11], s93 offen offset:3072 lds
  s_add_u32 s20, s66, s59
  s_addc_u32 s21, s67, 0
  s_lshl_b32 s58, s3, 22
  s_add_u32 s58, s58, 0x100000
  s_add_u32 s36, s82, s58
  s_addc_u32 s37, s83, 0
  s_load_dword s94, s[36:37], 0
  s_add_u32 s36, s36, 0x200000
  s_addc_u32 s37, s37, 0
  s_load_dword s94, s[36:37], 0
  s_cmp_eq_u32 s6, 0
  s_cselect_b32 s36, s76, s68
  s_cselect_b32 s37, s77, s69
  s_cselect_b32 s38, s78, s80
  s_cselect_b32 s39, s79, s81
  s_cmp_eq_u32 s7, 0
  s_cselect_b32 s36, s36, s38
  s_cselect_b32 s37, s37, s39
  s_load_dword s94, s[36:37], 0
  s_cselect_b32 s36, s72, s74
  s_cselect_b32 s37, s73, s75
  s_load_dword s94, s[36:37], 0
  s_mov_b32 s12, s82
  s_mov_b32 s13, s83
  s_mov_b32 s14, 17825792
  s_mov_b32 s15, 0x20000
  s_lshr_b32 s92, s2, 3
  s_and_b32 s57, s2, 1
  s_lshl1_add_u32 s92, s92, s57
  s_add_u32 s92, s92, 1
  s_and_b32 s57, s2, 0xc6
  s_cselect_b32 s92, 0, s92
  s_cbranch_scc1 L_nl_1
  v_and_b32 v140, 15, v0
  v_mov_b32 v141, 0x3c30
  v_lshrrev_b32 v140, v140, v141
  v_and_b32 v140, 1, v140
  v_cmp_eq_u32 vcc, 1, v140
  v_mov_b32 v136, 0
  v_mov_b32 v137, 0
  v_mov_b32 v138, 0
  v_mov_b32_e64 v139, 0
  v_mov_b32 v141, 1073741808
  v_cndmask_b32 v140, v141, v67, vcc
  s_lshl_b32 s57, s92, 15
  s_add_u32 s57, s57, 16220160
  buffer_store_dwordx4 v[136:139], v140, s[12:15], s57 offen sc1
L_nl_1:
  s_add_u32 m0, s56, 16384
  s_cmp_eq_u32 s7, 0
  s_cselect_b32 s93, s48, s49
  s_mul_i32 s93, s93, 172032
  s_add_u32 s93, s93, s91
  buffer_load_dwordx4 v10, s[20:23], s93 offen offset:0 lds
  s_lshl1_add_u32 s57, s5, s4
  s_mul_i32 s58, s57, 52
  s_lshr_b32 s58, s58, 8
  s_mul_i32 s58, s58, 5
  s_sub_u32 s57, s57, s58
  s_add_u32 s50, s57, 2
  s_add_u32 s51, s50, 1
  s_cmp_eq_u32 s51, 7
  s_cselect_b32 s51, 2, s51
  s_add_u32 s52, s51, 1
  s_cmp_eq_u32 s52, 7
  s_cselect_b32 s52, 2, s52
  s_add_u32 s53, s52, 1
  s_cmp_eq_u32 s53, 7
  s_cselect_b32 s53, 2, s53
  s_add_u32 s54, s53, 1
  s_cmp_eq_u32 s54, 7
  s_cselect_b32 s54, 2, s54
  v_lshrrev_b32 v51, 5, v1
  buffer_load_dwordx4 v11, s[20:23], s93 offen offset:1024 lds
  v_and_b32 v53, 31, v1
  v_lshlrev_b32_e64 v50, 4, v1
  s_xor_b32 s1, s6, s7
  v_bfe_u32 v128, v1, 1, 3
  v_xor_b32 v128, v128, v51
  s_lshl_b32 s57, s1, 1
  v_xor_b32 v128, s57, v128
  s_lshl_b32 s57, s6, 13
  v_lshlrev_b32 v129, 7, v53
  v_add_u32 v129, s57, v129
  v_xor_b32_e64 v130, 0, v128
  v_lshl_add_u32 v18, v130, 4, v129
  v_xor_b32_e64 v130, 2, v128
  v_lshl_add_u32 v19, v130, 4, v129
  v_xor_b32_e64 v130, 4, v128
  v_lshl_add_u32 v20, v130, 4, v129
  v_xor_b32_e64 v130, 6, v128
  v_lshl_add_u32 v21, v130, 4, v129
  v_and_b32_e64 v131, 1, v64
  buffer_load_dwordx4 v12, s[20:23], s93 offen offset:2048 lds
  v_bfe_u32 v128, v1, 2, 2
  v_lshl_add_u32 v128, v51, 3, v128
  v_lshlrev_b32 v128, 7, v128
  v_and_b32 v129, 3, v1
  v_lshl_add_u32 v132, v129, 3, v128
  s_lshl_b32 s58, s1, 11
  v_add_u32 v132, s58, v132
  v_bfe_u32 v128, v1, 3, 1
  v_lshl_or_b32 v128, v131, 1, v128
  v_lshl_add_u32 v129, v131, 13, v132
  s_lshl_b32 s57, s7, 1
  v_xor_b32 v130, s57, v128
  v_lshl_add_u32 v30, v130, 5, v129
  v_xor_b32 v31, 0x800, v30
  s_add_u32 s57, s57, 1
  v_xor_b32 v130, s57, v128
  v_lshl_add_u32 v32, v130, 5, v129
  v_xor_b32 v33, 0x800, v32
  v_lshrrev_b32_e64 v129, 2, v1
  buffer_load_dwordx4 v13, s[20:23], s93 offen offset:3072 lds
  v_xor_b32 v129, v64, v129
  v_and_b32 v129, 1, v129
  v_cmp_eq_u32_e64 vcc, 0, v129
  v_mov_b32 v129, 0x3f803f80
  v_xor_b32 v130, s7, v128
  v_cndmask_b32 v80, 0, v129, vcc
  v_cndmask_b32 v81, 0, v129, vcc
  v_cndmask_b32 v82, 0, v129, vcc
  v_cndmask_b32_e64 v83, 0, v129, vcc
  v_lshl_add_u32 v42, v130, 5, v132
  v_xor_b32 v43, 0x800, v42
  v_add_u32 v22, 65536, v18
  v_add_u32 v23, 65536, v19
  v_add_u32 v24, 65536, v20
  v_add_u32 v25, 65536, v21
  v_add_u32 v34, 65536, v30
  v_add_u32 v36, 65536, v32
  v_add_u32 v44, 65536, v42
  v_add_u32 v35, 65536, v31
  s_add_u32 m0, s56, 32768
  s_lshl_b32 s93, s49, 7
  buffer_load_dwordx4 v2, s[8:11], s93 offen offset:0 lds
  v_add_u32 v37, 65536, v33
  v_add_u32 v45, 65536, v43
  v_add_u32 v26, 131072, v18
  v_add_u32 v27, 131072, v19
  v_add_u32 v28, 131072, v20
  v_add_u32 v29, 131072, v21
  v_add_u32 v38, 131072, v30
  v_add_u32 v40, 131072, v32
  v_add_u32 v46, 131072, v42
  v_add_u32 v39, 131072, v31
  v_add_u32 v41, 131072, v33
  v_add_u32 v47, 131072, v43
  s_cmp_eq_u32 s7, 0
  s_cselect_b32 s24, s72, s74
  s_cselect_b32 s25, s73, s75
  s_cmp_eq_u32 s61, 1
  s_cselect_b32 s16, s66, s24
  s_cselect_b32 s17, s67, s25
  s_add_u32 s16, s16, s60
  s_addc_u32 s17, s17, 0
  buffer_load_dwordx4 v3, s[8:11], s93 offen offset:1024 lds
  s_mul_i32 s18, s55, 448
  s_sub_u32 s18, s18, s60
  s_mov_b32 s19, 0x20000
  s_lshl_b32 s58, s7, 2
  v_xor_b32 v66, s58, v65
  v_mul_lo_u32 v6, v62, s55
  v_lshl_add_u32 v6, v66, 4, v6
  s_lshl_b32 s58, s55, 3
  s_sub_u32 s58, s58, 1024
  v_add_u32 v7, s58, v6
  v_add_u32 v8, s58, v7
  v_add_u32 v9, s58, v8
  s_mul_i32 s90, s55, s6
  s_lshl_b32 s90, s90, 5
  s_lshl_b32 s55, s55, 6
  s_lshl_b32 s60, s63, 7
  s_add_u32 s24, s24, s60
  s_addc_u32 s25, s25, 0
  s_sub_u32 s26, 1605632, s60
  buffer_load_dwordx4 v4, s[8:11], s93 offen offset:2048 lds
  s_mov_b32 s27, 0x20000
  v_mul_u32_u24 v14, 3584, v62
  v_lshl_add_u32 v14, v66, 4, v14
  v_add_u32 v15, 27648, v14
  v_add_u32 v16, 55296, v14
  v_add_u32 v17, 82944, v14
  s_mul_i32 s0, s6, 114688
  s_lshl4_add_u32 s95, s4, s5
  s_lshl1_add_u32 s57, s4, s6
  s_lshl_b32 s57, s57, 9
  v_lshlrev_b32 v128, 3, v53
  v_add_u32_e64 v128, s57, v128
  v_mul_u32_u24 v49, 16640, v51
  v_add_u32_e64 v49, v49, v128
  v_mov_b32 v78, 1073741808
  v_mov_b32_e64 v79, 1
  s_mov_b32 s32, s80
  s_mov_b32 s33, s81
  s_mov_b32 s34, 256
  buffer_load_dwordx4 v5, s[8:11], s93 offen offset:3072 lds
  s_mov_b32 s35, 0x20000
  s_mov_b32 s28, s82
  s_mov_b32 s29, s83
  s_mov_b32 s31, 0x20000
  s_cmp_eq_u32 s5, 3
  s_cselect_b32 s30, 0, 17825792
  s_mov_b32 s84, s82
  s_mov_b32 s85, s83
  s_mov_b32 s87, 0x20000
  s_cmp_eq_u32 s5, 15
  s_cselect_b32 s86, 0, 17825792
  s_and_b32 s57, s2, 7
  s_bfe_u32 s58, s2, 0x20003
  s_lshl2_add_u32 s70, s57, s58
  s_lshr_b32 s71, s2, 5
  s_lshl_b32 s57, s71, 7
  s_add_u32 s36, s76, s57
  s_addc_u32 s37, s77, 0
  s_sub_u32 s38, 1605632, s57
  s_add_u32 m0, s56, 49152
  s_lshl_b32 s93, s50, 7
  buffer_load_dwordx4 v2, s[8:11], s93 offen offset:0 lds
  s_mov_b32 s39, 0x20000
  s_add_u32 s40, s68, s57
  s_addc_u32 s41, s69, 0
  s_sub_u32 s42, 401408, s57
  s_mov_b32 s43, 0x20000
  s_mov_b32 s44, s78
  s_mov_b32 s45, s79
  s_mov_b32 s46, 1835008
  s_mov_b32 s47, 0x20000
  s_mul_i32 s100, s3, 344064
  s_mul_i32 s101, s3, 57344
  s_add_u32 s101, s101, 1376256
  v_lshlrev_b32 v128, 2, v131
  v_xor_b32_e64 v128, v128, v63
  v_mul_u32_u24 v129, 896, v62
  v_lshl_add_u32 v74, v128, 4, v129
  v_add_u32 v75, 6144, v74
  v_add_u32 v76, 12288, v74
  v_add_u32 v77, 18432, v74
  buffer_load_dwordx4 v3, s[8:11], s93 offen offset:1024 lds
  s_cmp_eq_u32 s5, 15
  s_cselect_b32 s57, 63, s89
  v_bfe_u32 v128, v1, 4, 1
  v_add_u32 v128, s57, v128
  v_mul_u32_u24 v129, 37, v128
  v_lshrrev_b32 v129, 8, v129
  v_mul_u32_u24 v130, 7, v129
  v_sub_u32_e64 v128, v128, v130
  v_mul_u32_u24 v130, 2341, v128
  v_lshrrev_b32 v130, 10, v130
  v_and_b32 v132, 3, v1
  v_add_u32 v130, v130, v132
  v_mul_u32_u24 v132, 28, v130
  v_lshrrev_b32 v132, 6, v132
  v_cmp_le_u32 vcc, v132, v128
  v_sub_u32_e64 v128, v128, v132
  v_bfe_u32 v132, v1, 2, 2
  v_cmp_gt_u32 s[96:97], 16, v0
  s_nop 0
  s_and_b64 vcc, vcc, s[96:97]
  buffer_load_dwordx4 v4, s[8:11], s93 offen offset:2048 lds
  v_cmp_gt_u32 s[96:97], 16, v130
  s_nop 0
  s_and_b64 vcc, vcc, s[96:97]
  v_min_u32 v48, 1, v129
  v_lshlrev_b32 v48, 1, v48
  v_cmp_le_u32 s[96:97], v132, v48
  s_nop 0
  s_and_b64 vcc, vcc, s[96:97]
  v_lshl_add_u32 v128, v132, 1, v128
  v_add_u32 v128, v128, v48
  v_lshrrev_b32 v129, 1, v129
  v_lshl_add_u32 v128, v129, 7, v128
  v_add_u32_e64 v132, s4, v132
  v_cmp_gt_u32 s[96:97], 16, v132
  s_nop 0
  s_and_b64 vcc, vcc, s[96:97]
  v_lshl_add_u32 v130, v132, 4, v130
  v_lshl_add_u32 v128, v130, 11, v128
  v_add_u32 v128, 16253440, v128
  v_cndmask_b32_e64 v48, v78, v128, vcc
  s_cmp_eq_u32 s5, 3
  s_cselect_b32 s57, 63, s88
  v_bfe_u32 v128, v1, 4, 1
  v_add_u32 v128, s57, v128
  v_mul_u32_u24 v129, 37, v128
  v_lshrrev_b32 v129, 8, v129
  v_mul_u32_u24 v130, 7, v129
  v_sub_u32_e64 v128, v128, v130
  v_mul_u32_u24 v130, 2341, v128
  v_lshrrev_b32 v130, 10, v130
  v_and_b32 v132, 3, v1
  v_add_u32 v130, v130, v132
  v_mul_u32_u24 v132, 28, v130
  v_lshrrev_b32 v132, 6, v132
  v_cmp_le_u32 vcc, v132, v128
  v_sub_u32_e64 v128, v128, v132
  v_bfe_u32 v132, v1, 2, 2
  v_cmp_gt_u32 s[96:97], 32, v0
  s_nop 0
  s_and_b64 vcc, vcc, s[96:97]
  v_cmp_gt_u32 s[96:97], 16, v130
  s_nop 0
  s_and_b64 vcc, vcc, s[96:97]
  v_min_u32 v71, 1, v129
  v_lshlrev_b32 v71, 1, v71
  v_cmp_le_u32 s[96:97], v132, v71
  s_nop 0
  s_and_b64 vcc, vcc, s[96:97]
  v_lshl_add_u32 v128, v132, 1, v128
  v_add_u32 v128, v128, v71
  v_lshrrev_b32 v129, 1, v129
  v_lshl_add_u32 v128, v129, 7, v128
  v_add_u32_e64 v132, s4, v132
  v_cmp_gt_u32 s[96:97], 16, v132
  s_nop 0
  s_and_b64 vcc, vcc, s[96:97]
  v_lshl_add_u32 v130, v132, 4, v130
  v_lshl_add_u32 v128, v130, 11, v128
  v_add_u32 v128, 16253440, v128
  v_cndmask_b32 v71, v78, v128, vcc
  s_mul_i32 s57, s5, 28
  s_add_u32 s58, s57, 27
  s_xor_b32 s57, s57, s58
  s_lshr_b32 s57, s57, 6
  s_cmp_lg_u32 s57, 0
  s_cselect_b32 s57, 0x0101, 1
  s_lshl_b32 s58, s57, 16
  s_mov_b32 s69, s58
  s_or_b32 s68, s57, s58
  s_cmp_ge_u32 s4, 1
  s_cselect_b32 s73, s57, 0
  s_cmp_ge_u32 s4, 2
  s_cselect_b32 s58, s58, 0
  s_or_b32 s73, s73, s58
  s_lshl_b32 s57, s95, 11
  s_add_u32 s57, s57, 16253440
  s_add_u32 s64, s82, s57
  s_addc_u32 s65, s83, 0
  s_lshl3_add_u32 s57, s70, s71
  s_lshl_b32 s57, s57, 11
  s_lshl_b32 s58, s3, 7
  s_add_u32 s57, s57, s58
  s_add_u32 s57, s57, 16254208
  s_add_u32 s66, s82, s57
  s_addc_u32 s67, s83, 0
  v_mov_b32 v69, 3
  s_waitcnt vmcnt(7)
  s_barrier
  ds_read_b64_tr_b16 a[224:225], v42 offset:16384
  ds_read_b64_tr_b16 a[226:227], v42 offset:16896
  ds_read_b128 a[0:3], v18 offset:0
  ds_read_b128 a[4:7], v18 offset:4096
  ds_read_b64_tr_b16 a[232:233], v43 offset:16384
  ds_read_b64_tr_b16 a[234:235], v43 offset:16896
  ds_read_b128 a[8:11], v19 offset:0
  ds_read_b128 a[12:15], v19 offset:4096
  s_waitcnt lgkmcnt(4)
  v_mfma_f32_32x32x16_bf16 v[96:111], a[224:227], a[0:3], 0
  ds_read_b64_tr_b16 a[240:241], v42 offset:20480
  ds_read_b64_tr_b16 a[242:243], v42 offset:20992
  v_mfma_f32_32x32x16_bf16 v[112:127], a[224:227], a[4:7], 0
  ds_read_b128 a[16:19], v20 offset:0
  ds_read_b128 a[20:23], v20 offset:4096
  buffer_load_dwordx4 v5, s[8:11], s93 offen offset:3072 lds
  v_mfma_f32_16x16x32_bf16 v[92:95], v[80:83], a[224:227], 0
  v_mfma_f32_16x16x32_bf16 v[192:195], v[80:83], a[0:3], 0
  v_mfma_f32_16x16x32_bf16 v[196:199], v[80:83], a[4:7], 0
  s_waitcnt lgkmcnt(4)
  v_mfma_f32_32x32x16_bf16 v[96:111], a[232:235], a[8:11], v[96:111]
  ds_read_b64_tr_b16 a[224:225], v43 offset:20480
  ds_read_b64_tr_b16 a[226:227], v43 offset:20992
  v_mfma_f32_32x32x16_bf16 v[112:127], a[232:235], a[12:15], v[112:127]
  ds_read_b128 a[24:27], v21 offset:0
  ds_read_b128 a[28:31], v21 offset:4096
  s_add_u32 m0, s56, 131072
  s_cmp_eq_u32 s7, 0
  s_cselect_b32 s93, s50, s51
  s_mul_i32 s93, s93, 172032
  s_add_u32 s93, s93, s91
  buffer_load_dwordx4 v10, s[20:23], s93 offen offset:0 lds
  v_mfma_f32_32x32x16_bf16 v[208:223], a[0:3], a[0:3], 0
  buffer_load_dwordx4 v11, s[20:23], s93 offen offset:1024 lds
  v_mfma_f32_32x32x16_bf16 v[224:239], a[4:7], a[4:7], 0
  buffer_load_dwordx4 v12, s[20:23], s93 offen offset:2048 lds
  s_waitcnt lgkmcnt(4)
  v_mfma_f32_32x32x16_bf16 v[96:111], a[240:243], a[16:19], v[96:111]
  s_waitcnt vmcnt(7)
  s_barrier
  ds_read_b64_tr_b16 a[232:233], v42 offset:24576
  ds_read_b64_tr_b16 a[234:235], v42 offset:25088
  v_mfma_f32_32x32x16_bf16 v[112:127], a[240:243], a[20:23], v[112:127]
  ds_read_b128 a[32:35], v18 offset:32768
  ds_read_b128 a[36:39], v18 offset:36864
  buffer_load_dwordx4 v13, s[20:23], s93 offen offset:3072 lds
  v_mfma_f32_16x16x32_bf16 v[92:95], v[80:83], a[240:243], v[92:95]
  v_mfma_f32_16x16x32_bf16 v[192:195], v[80:83], a[16:19], v[192:195]
  v_mfma_f32_16x16x32_bf16 v[196:199], v[80:83], a[20:23], v[196:199]
  s_waitcnt lgkmcnt(4)
  v_mfma_f32_32x32x16_bf16 v[96:111], a[224:227], a[24:27], v[96:111]
  ds_read_b64_tr_b16 a[240:241], v43 offset:24576
  ds_read_b64_tr_b16 a[242:243], v43 offset:25088
  s_cmp_eq_u32 s92, 0
  s_cbranch_scc1 L_ns_2
  v_lshlrev_b32 v63, 10, v0
  s_lshl_b32 s57, s92, 4
  s_sub_u32 s57, s57, 16
  buffer_store_dword v79, v63, s[32:35], s57 offen sc1
L_ns_2:
  v_mfma_f32_32x32x16_bf16 v[112:127], a[224:227], a[28:31], v[112:127]
  ds_read_b128 a[40:43], v19 offset:32768
  ds_read_b128 a[44:47], v19 offset:36864
  s_add_u32 m0, s56, 114688
  s_lshl_b32 s93, s51, 7
  buffer_load_dwordx4 v2, s[8:11], s93 offen offset:0 lds
  v_mfma_f32_32x32x16_bf16 v[208:223], a[16:19], a[16:19], v[208:223]
  buffer_load_dwordx4 v3, s[8:11], s93 offen offset:1024 lds
  v_mfma_f32_32x32x16_bf16 v[224:239], a[20:23], a[20:23], v[224:239]
  buffer_load_dwordx4 v4, s[8:11], s93 offen offset:2048 lds
  s_waitcnt lgkmcnt(4)
  v_mfma_f32_32x32x16_bf16 v[96:111], a[232:235], a[32:35], v[96:111]
  ds_read_b64_tr_b16 a[224:225], v42 offset:28672
  ds_read_b64_tr_b16 a[226:227], v42 offset:29184
  v_mfma_f32_32x32x16_bf16 v[112:127], a[232:235], a[36:39], v[112:127]
  ds_read_b128 a[48:51], v20 offset:32768
  ds_read_b128 a[52:55], v20 offset:36864
  buffer_load_dwordx4 v5, s[8:11], s93 offen offset:3072 lds
  v_mfma_f32_16x16x32_bf16 v[92:95], v[80:83], a[232:235], v[92:95]
  v_mfma_f32_16x16x32_bf16 v[192:195], v[80:83], a[32:35], v[192:195]
  v_mfma_f32_16x16x32_bf16 v[196:199], v[80:83], a[36:39], v[196:199]
  s_waitcnt lgkmcnt(4)
  v_mfma_f32_32x32x16_bf16 v[96:111], a[240:243], a[40:43], v[96:111]
  ds_read_b64_tr_b16 a[232:233], v43 offset:28672
  ds_read_b64_tr_b16 a[234:235], v43 offset:29184
  v_mfma_f32_32x32x16_bf16 v[112:127], a[240:243], a[44:47], v[112:127]
  ds_read_b128 a[56:59], v21 offset:32768
  ds_read_b128 a[60:63], v21 offset:36864
  s_add_u32 m0, s56, 98304
  s_lshl_b32 s93, s52, 7
  buffer_load_dwordx4 v2, s[8:11], s93 offen offset:0 lds
  v_mfma_f32_32x32x16_bf16 v[208:223], a[32:35], a[32:35], v[208:223]
  buffer_load_dwordx4 v3, s[8:11], s93 offen offset:1024 lds
  v_mfma_f32_32x32x16_bf16 v[224:239], a[36:39], a[36:39], v[224:239]
  buffer_load_dwordx4 v4, s[8:11], s93 offen offset:2048 lds
  s_waitcnt lgkmcnt(4)
  v_mfma_f32_32x32x16_bf16 v[96:111], a[224:227], a[48:51], v[96:111]
  s_waitcnt vmcnt(7)
  s_barrier
  ds_read_b64_tr_b16 a[240:241], v46 offset:0
  ds_read_b64_tr_b16 a[242:243], v46 offset:512
  v_mfma_f32_32x32x16_bf16 v[112:127], a[224:227], a[52:55], v[112:127]
  ds_read_b128 a[64:67], v18 offset:49152
  ds_read_b128 a[68:71], v18 offset:53248
  buffer_load_dwordx4 v5, s[8:11], s93 offen offset:3072 lds
  v_mfma_f32_16x16x32_bf16 v[92:95], v[80:83], a[224:227], v[92:95]
  v_mfma_f32_16x16x32_bf16 v[192:195], v[80:83], a[48:51], v[192:195]
  v_mfma_f32_16x16x32_bf16 v[196:199], v[80:83], a[52:55], v[196:199]
  s_waitcnt lgkmcnt(4)
  v_mfma_f32_32x32x16_bf16 v[96:111], a[232:235], a[56:59], v[96:111]
  ds_read_b64_tr_b16 a[224:225], v47 offset:0
  ds_read_b64_tr_b16 a[226:227], v47 offset:512
  v_mfma_f32_32x32x16_bf16 v[112:127], a[232:235], a[60:63], v[112:127]
  ds_read_b128 a[72:75], v19 offset:49152
  ds_read_b128 a[76:79], v19 offset:53248
  s_add_u32 m0, s56, 81920
  s_cmp_eq_u32 s7, 0
  s_cselect_b32 s93, s52, s53
  s_mul_i32 s93, s93, 172032
  s_add_u32 s93, s93, s91
  buffer_load_dwordx4 v10, s[20:23], s93 offen offset:0 lds
  v_mfma_f32_32x32x16_bf16 v[208:223], a[48:51], a[48:51], v[208:223]
  buffer_load_dwordx4 v11, s[20:23], s93 offen offset:1024 lds
  v_mfma_f32_32x32x16_bf16 v[224:239], a[52:55], a[52:55], v[224:239]
  buffer_load_dwordx4 v12, s[20:23], s93 offen offset:2048 lds
  s_waitcnt lgkmcnt(4)
  v_mfma_f32_32x32x16_bf16 v[96:111], a[240:243], a[64:67], v[96:111]
  ds_read_b64_tr_b16 a[232:233], v46 offset:4096
  ds_read_b64_tr_b16 a[234:235], v46 offset:4608
  v_mfma_f32_32x32x16_bf16 v[112:127], a[240:243], a[68:71], v[112:127]
  ds_read_b128 a[80:83], v20 offset:49152
  ds_read_b128 a[84:87], v20 offset:53248
  buffer_load_dwordx4 v13, s[20:23], s93 offen offset:3072 lds
  v_mfma_f32_16x16x32_bf16 v[92:95], v[80:83], a[240:243], v[92:95]
  v_mfma_f32_16x16x32_bf16 v[192:195], v[80:83], a[64:67], v[192:195]
  v_mfma_f32_16x16x32_bf16 v[196:199], v[80:83], a[68:71], v[196:199]
  s_waitcnt lgkmcnt(4)
  v_mfma_f32_32x32x16_bf16 v[96:111], a[224:227], a[72:75], v[96:111]
  ds_read_b64_tr_b16 a[240:241], v47 offset:4096
  ds_read_b64_tr_b16 a[242:243], v47 offset:4608
  v_mfma_f32_32x32x16_bf16 v[112:127], a[224:227], a[76:79], v[112:127]
  ds_read_b128 a[88:91], v21 offset:49152
  ds_read_b128 a[92:95], v21 offset:53248
  s_add_u32 m0, s56, 65536
  s_lshl_b32 s93, s53, 7
  buffer_load_dwordx4 v2, s[8:11], s93 offen offset:0 lds
  v_mfma_f32_32x32x16_bf16 v[208:223], a[64:67], a[64:67], v[208:223]
  buffer_load_dwordx4 v3, s[8:11], s93 offen offset:1024 lds
  v_mfma_f32_32x32x16_bf16 v[224:239], a[68:71], a[68:71], v[224:239]
  buffer_load_dwordx4 v4, s[8:11], s93 offen offset:2048 lds
  s_waitcnt lgkmcnt(4)
  v_mfma_f32_32x32x16_bf16 v[96:111], a[232:235], a[80:83], v[96:111]
  s_waitcnt vmcnt(11)
  s_barrier
  ds_read_b64_tr_b16 a[224:225], v46 offset:8192
  ds_read_b64_tr_b16 a[226:227], v46 offset:8704
  v_mfma_f32_32x32x16_bf16 v[112:127], a[232:235], a[84:87], v[112:127]
  ds_read_b128 a[96:99], v22 offset:49152
  ds_read_b128 a[100:103], v22 offset:53248
  buffer_load_dwordx4 v5, s[8:11], s93 offen offset:3072 lds
  v_mfma_f32_16x16x32_bf16 v[92:95], v[80:83], a[232:235], v[92:95]
  v_mfma_f32_16x16x32_bf16 v[192:195], v[80:83], a[80:83], v[192:195]
  v_mfma_f32_16x16x32_bf16 v[196:199], v[80:83], a[84:87], v[196:199]
  s_waitcnt lgkmcnt(4)
  v_mfma_f32_32x32x16_bf16 v[96:111], a[240:243], a[88:91], v[96:111]
  ds_read_b64_tr_b16 a[232:233], v47 offset:8192
  ds_read_b64_tr_b16 a[234:235], v47 offset:8704
  v_mfma_f32_32x32x16_bf16 v[112:127], a[240:243], a[92:95], v[112:127]
  ds_read_b128 a[104:107], v23 offset:49152
  ds_read_b128 a[108:111], v23 offset:53248
  s_add_u32 m0, s56, 0
  s_lshl_b32 s93, s54, 7
  buffer_load_dwordx4 v2, s[8:11], s93 offen offset:0 lds
  v_mfma_f32_32x32x16_bf16 v[208:223], a[80:83], a[80:83], v[208:223]
  buffer_load_dwordx4 v3, s[8:11], s93 offen offset:1024 lds
  v_mfma_f32_32x32x16_bf16 v[224:239], a[84:87], a[84:87], v[224:239]
  buffer_load_dwordx4 v4, s[8:11], s93 offen offset:2048 lds
  s_waitcnt lgkmcnt(4)
  v_mfma_f32_32x32x16_bf16 v[96:111], a[224:227], a[96:99], v[96:111]
  ds_read_b64_tr_b16 a[240:241], v46 offset:12288
  ds_read_b64_tr_b16 a[242:243], v46 offset:12800
  v_mfma_f32_32x32x16_bf16 v[112:127], a[224:227], a[100:103], v[112:127]
  ds_read_b128 a[112:115], v24 offset:49152
  ds_read_b128 a[116:119], v24 offset:53248
  buffer_load_dwordx4 v5, s[8:11], s93 offen offset:3072 lds
  v_mfma_f32_16x16x32_bf16 v[92:95], v[80:83], a[224:227], v[92:95]
  v_mfma_f32_16x16x32_bf16 v[192:195], v[80:83], a[96:99], v[192:195]
  v_mfma_f32_16x16x32_bf16 v[196:199], v[80:83], a[100:103], v[196:199]
  s_waitcnt lgkmcnt(4)
  v_mfma_f32_32x32x16_bf16 v[96:111], a[232:235], a[104:107], v[96:111]
  ds_read_b64_tr_b16 a[224:225], v47 offset:12288
  ds_read_b64_tr_b16 a[226:227], v47 offset:12800
  v_mfma_f32_32x32x16_bf16 v[112:127], a[232:235], a[108:111], v[112:127]
  ds_read_b128 a[120:123], v25 offset:49152
  ds_read_b128 a[124:127], v25 offset:53248
  s_add_u32 m0, s56, 32768
  s_cmp_eq_u32 s7, 0
  s_cselect_b32 s93, s54, 64
  s_mul_i32 s93, s93, 172032
  s_add_u32 s93, s93, s91
  buffer_load_dwordx4 v10, s[20:23], s93 offen offset:0 lds
  v_mfma_f32_32x32x16_bf16 v[208:223], a[96:99], a[96:99], v[208:223]
  buffer_load_dwordx4 v11, s[20:23], s93 offen offset:1024 lds
  v_mfma_f32_32x32x16_bf16 v[224:239], a[100:103], a[100:103], v[224:239]
  buffer_load_dwordx4 v12, s[20:23], s93 offen offset:2048 lds
  s_waitcnt lgkmcnt(4)
  v_mfma_f32_32x32x16_bf16 v[96:111], a[240:243], a[112:115], v[96:111]
  s_waitcnt vmcnt(11)
  s_barrier
  ds_read_b64_tr_b16 a[232:233], v44 offset:16384
  ds_read_b64_tr_b16 a[234:235], v44 offset:16896
  v_mfma_f32_32x32x16_bf16 v[112:127], a[240:243], a[116:119], v[112:127]
  ds_read_b128 a[128:131], v22 offset:32768
  ds_read_b128 a[132:135], v22 offset:36864
  buffer_load_dwordx4 v13, s[20:23], s93 offen offset:3072 lds
  v_mfma_f32_16x16x32_bf16 v[92:95], v[80:83], a[240:243], v[92:95]
  v_mfma_f32_16x16x32_bf16 v[192:195], v[80:83], a[112:115], v[192:195]
  v_mfma_f32_16x16x32_bf16 v[196:199], v[80:83], a[116:119], v[196:199]
  s_waitcnt lgkmcnt(4)
  v_mfma_f32_32x32x16_bf16 v[96:111], a[224:227], a[120:123], v[96:111]
  ds_read_b64_tr_b16 a[240:241], v45 offset:16384
  ds_read_b64_tr_b16 a[242:243], v45 offset:16896
  v_mfma_f32_32x32x16_bf16 v[112:127], a[224:227], a[124:127], v[112:127]
  ds_read_b128 a[136:139], v23 offset:32768
  ds_read_b128 a[140:143], v23 offset:36864
  s_add_u32 m0, s56, 16384
  s_mul_i32 s93, s50, s55
  s_add_u32 s93, s93, s90
  buffer_load_dwordx4 v6, s[16:19], s93 offen offset:0 lds
  v_mfma_f32_32x32x16_bf16 v[208:223], a[112:115], a[112:115], v[208:223]
  buffer_load_dwordx4 v7, s[16:19], s93 offen offset:1024 lds
  v_mfma_f32_32x32x16_bf16 v[224:239], a[116:119], a[116:119], v[224:239]
  buffer_load_dwordx4 v8, s[16:19], s93 offen offset:2048 lds
  s_waitcnt lgkmcnt(4)
  v_mfma_f32_32x32x16_bf16 v[96:111], a[232:235], a[128:131], v[96:111]
  ds_read_b64_tr_b16 a[224:225], v44 offset:20480
  ds_read_b64_tr_b16 a[226:227], v44 offset:20992
  v_mfma_f32_32x32x16_bf16 v[112:127], a[232:235], a[132:135], v[112:127]
  ds_read_b128 a[144:147], v24 offset:32768
  ds_read_b128 a[148:151], v24 offset:36864
  buffer_load_dwordx4 v9, s[16:19], s93 offen offset:3072 lds
  v_mfma_f32_16x16x32_bf16 v[92:95], v[80:83], a[232:235], v[92:95]
  v_mfma_f32_16x16x32_bf16 v[192:195], v[80:83], a[128:131], v[192:195]
  v_mfma_f32_16x16x32_bf16 v[196:199], v[80:83], a[132:135], v[196:199]
  s_waitcnt lgkmcnt(4)
  v_mfma_f32_32x32x16_bf16 v[96:111], a[240:243], a[136:139], v[96:111]
  ds_read_b64_tr_b16 a[232:233], v45 offset:20480
  ds_read_b64_tr_b16 a[234:235], v45 offset:20992
  v_mfma_f32_32x32x16_bf16 v[112:127], a[240:243], a[140:143], v[112:127]
  ds_read_b128 a[152:155], v25 offset:32768
  ds_read_b128 a[156:159], v25 offset:36864
  s_add_u32 m0, s56, 49152
  s_mul_i32 s93, s51, s55
  s_add_u32 s93, s93, s90
  buffer_load_dwordx4 v6, s[16:19], s93 offen offset:0 lds
  v_mfma_f32_32x32x16_bf16 v[208:223], a[128:131], a[128:131], v[208:223]
  buffer_load_dwordx4 v7, s[16:19], s93 offen offset:1024 lds
  v_mfma_f32_32x32x16_bf16 v[224:239], a[132:135], a[132:135], v[224:239]
  buffer_load_dwordx4 v8, s[16:19], s93 offen offset:2048 lds
  s_waitcnt lgkmcnt(4)
  v_mfma_f32_32x32x16_bf16 v[96:111], a[224:227], a[144:147], v[96:111]
  s_waitcnt vmcnt(15)
  s_barrier
  ds_read_b64_tr_b16 a[240:241], v44 offset:24576
  ds_read_b64_tr_b16 a[242:243], v44 offset:25088
  v_mfma_f32_32x32x16_bf16 v[112:127], a[224:227], a[148:151], v[112:127]
  ds_read_b128 a[160:163], v22 offset:0
  ds_read_b128 a[164:167], v22 offset:4096
  buffer_load_dwordx4 v9, s[16:19], s93 offen offset:3072 lds
  v_mfma_f32_16x16x32_bf16 v[92:95], v[80:83], a[224:227], v[92:95]
  v_mfma_f32_16x16x32_bf16 v[192:195], v[80:83], a[144:147], v[192:195]
  v_mfma_f32_16x16x32_bf16 v[196:199], v[80:83], a[148:151], v[196:199]
  s_waitcnt lgkmcnt(4)
  v_mfma_f32_32x32x16_bf16 v[96:111], a[232:235], a[152:155], v[96:111]
  ds_read_b64_tr_b16 a[224:225], v45 offset:24576
  ds_read_b64_tr_b16 a[226:227], v45 offset:25088
  v_mfma_f32_32x32x16_bf16 v[112:127], a[232:235], a[156:159], v[112:127]
  ds_read_b128 a[168:171], v23 offset:0
  ds_read_b128 a[172:175], v23 offset:4096
  s_add_u32 m0, s56, 131072
  s_mul_i32 s93, s52, s55
  s_add_u32 s93, s93, s90
  buffer_load_dwordx4 v6, s[16:19], s93 offen offset:0 lds
  v_mfma_f32_32x32x16_bf16 v[208:223], a[144:147], a[144:147], v[208:223]
  buffer_load_dwordx4 v7, s[16:19], s93 offen offset:1024 lds
  v_mfma_f32_32x32x16_bf16 v[224:239], a[148:151], a[148:151], v[224:239]
  buffer_load_dwordx4 v8, s[16:19], s93 offen offset:2048 lds
  s_waitcnt lgkmcnt(4)
  v_mfma_f32_32x32x16_bf16 v[96:111], a[240:243], a[160:163], v[96:111]
  ds_read_b64_tr_b16 a[232:233], v44 offset:28672
  ds_read_b64_tr_b16 a[234:235], v44 offset:29184
  v_mfma_f32_32x32x16_bf16 v[112:127], a[240:243], a[164:167], v[112:127]
  ds_read_b128 a[176:179], v24 offset:0
  ds_read_b128 a[180:183], v24 offset:4096
  buffer_load_dwordx4 v9, s[16:19], s93 offen offset:3072 lds
  v_mfma_f32_16x16x32_bf16 v[92:95], v[80:83], a[240:243], v[92:95]
  v_mfma_f32_16x16x32_bf16 v[192:195], v[80:83], a[160:163], v[192:195]
  v_mfma_f32_16x16x32_bf16 v[196:199], v[80:83], a[164:167], v[196:199]
  s_waitcnt lgkmcnt(4)
  v_mfma_f32_32x32x16_bf16 v[96:111], a[224:227], a[168:171], v[96:111]
  ds_read_b64_tr_b16 a[240:241], v45 offset:28672
  ds_read_b64_tr_b16 a[242:243], v45 offset:29184
  v_mfma_f32_32x32x16_bf16 v[112:127], a[224:227], a[172:175], v[112:127]
  ds_read_b128 a[184:187], v25 offset:0
  ds_read_b128 a[188:191], v25 offset:4096
  s_add_u32 m0, s56, 114688
  s_mul_i32 s93, s53, s55
  s_add_u32 s93, s93, s90
  buffer_load_dwordx4 v6, s[16:19], s93 offen offset:0 lds
  v_mfma_f32_32x32x16_bf16 v[208:223], a[160:163], a[160:163], v[208:223]
  buffer_load_dwordx4 v7, s[16:19], s93 offen offset:1024 lds
  v_mfma_f32_32x32x16_bf16 v[224:239], a[164:167], a[164:167], v[224:239]
  buffer_load_dwordx4 v8, s[16:19], s93 offen offset:2048 lds
  s_waitcnt lgkmcnt(4)
  v_mfma_f32_32x32x16_bf16 v[96:111], a[232:235], a[176:179], v[96:111]
  s_waitcnt vmcnt(15)
  s_barrier
  ds_read_b64_tr_b16 a[224:225], v42 offset:32768
  ds_read_b64_tr_b16 a[226:227], v42 offset:33280
  v_mfma_f32_32x32x16_bf16 v[112:127], a[232:235], a[180:183], v[112:127]
  ds_read_b128 a[192:195], v18 offset:0
  ds_read_b128 a[196:199], v18 offset:4096
  buffer_load_dwordx4 v9, s[16:19], s93 offen offset:3072 lds
  v_mfma_f32_16x16x32_bf16 v[92:95], v[80:83], a[232:235], v[92:95]
  v_mfma_f32_16x16x32_bf16 v[192:195], v[80:83], a[176:179], v[192:195]
  v_mfma_f32_16x16x32_bf16 v[196:199], v[80:83], a[180:183], v[196:199]
  s_waitcnt lgkmcnt(4)
  v_mfma_f32_32x32x16_bf16 v[96:111], a[240:243], a[184:187], v[96:111]
  ds_read_b64_tr_b16 a[232:233], v43 offset:32768
  ds_read_b64_tr_b16 a[234:235], v43 offset:33280
  v_mfma_f32_32x32x16_bf16 v[112:127], a[240:243], a[188:191], v[112:127]
  ds_read_b128 a[200:203], v19 offset:0
  ds_read_b128 a[204:207], v19 offset:4096
  s_add_u32 m0, s56, 98304
  s_mul_i32 s93, s54, s55
  s_add_u32 s93, s93, s90
  buffer_load_dwordx4 v6, s[16:19], s93 offen offset:0 lds
  v_mfma_f32_32x32x16_bf16 v[208:223], a[176:179], a[176:179], v[208:223]
  buffer_load_dwordx4 v7, s[16:19], s93 offen offset:1024 lds
  v_mfma_f32_32x32x16_bf16 v[224:239], a[180:183], a[180:183], v[224:239]
  buffer_load_dwordx4 v8, s[16:19], s93 offen offset:2048 lds
  s_waitcnt lgkmcnt(4)
  v_mfma_f32_32x32x16_bf16 v[96:111], a[224:227], a[192:195], v[96:111]
  ds_read_b64_tr_b16 a[240:241], v42 offset:36864
  ds_read_b64_tr_b16 a[242:243], v42 offset:37376
  v_mfma_f32_32x32x16_bf16 v[112:127], a[224:227], a[196:199], v[112:127]
  ds_read_b128 a[208:211], v20 offset:0
  ds_read_b128 a[212:215], v20 offset:4096
  buffer_load_dwordx4 v9, s[16:19], s93 offen offset:3072 lds
  v_mfma_f32_16x16x32_bf16 v[92:95], v[80:83], a[224:227], v[92:95]
  v_mfma_f32_16x16x32_bf16 v[192:195], v[80:83], a[192:195], v[192:195]
  v_mfma_f32_16x16x32_bf16 v[196:199], v[80:83], a[196:199], v[196:199]
  s_waitcnt lgkmcnt(4)
  v_mfma_f32_32x32x16_bf16 v[96:111], a[232:235], a[200:203], v[96:111]
  ds_read_b64_tr_b16 a[224:225], v43 offset:36864
  ds_read_b64_tr_b16 a[226:227], v43 offset:37376
  v_mfma_f32_32x32x16_bf16 v[112:127], a[232:235], a[204:207], v[112:127]
  ds_read_b128 a[216:219], v21 offset:0
  ds_read_b128 a[220:223], v21 offset:4096
  v_lshlrev_b32 v64, 7, v1
  s_mul_i32 s93, s2, 6272
  s_lshl_b32 s79, s71, 7
  s_sub_u32 s93, s93, s79
  s_cmp_lg_u32 s3, 0
  s_cbranch_scc1 L_t1_3
  buffer_load_dword v72, v64, s[36:39], s93 offen
L_t1_3:
  v_mfma_f32_32x32x16_bf16 v[208:223], a[192:195], a[192:195], v[208:223]
  s_mul_i32 s93, s2, 1664
  s_sub_u32 s93, s93, s79
  v_min_u32 v64, 1536, v64
  s_cmp_lg_u32 s3, 1
  s_cbranch_scc1 L_t2_4
  buffer_load_dword v72, v64, s[40:43], s93 offen
L_t2_4:
  v_mfma_f32_32x32x16_bf16 v[224:239], a[196:199], a[196:199], v[224:239]
  s_waitcnt lgkmcnt(4)
  v_mfma_f32_32x32x16_bf16 v[96:111], a[240:243], a[208:211], v[96:111]
  s_waitcnt vmcnt(16)
  s_barrier
  ds_read_b64_tr_b16 a[232:233], v30 offset:16384
  ds_read_b64_tr_b16 a[234:235], v30 offset:16896
  v_mfma_f32_32x32x16_bf16 v[112:127], a[240:243], a[212:215], v[112:127]
  ds_read_b64_tr_b16 a[236:237], v32 offset:16384
  ds_read_b64_tr_b16 a[238:239], v32 offset:16896
  s_add_u32 m0, s56, 81920
  s_mul_i32 s93, s48, s55
  s_add_u32 s93, s93, s90
  buffer_load_dwordx4 v6, s[16:19], s93 offen offset:0 lds
  v_mfma_f32_16x16x32_bf16 v[92:95], v[80:83], a[240:243], v[92:95]
  v_mfma_f32_16x16x32_bf16 v[192:195], v[80:83], a[208:211], v[192:195]
  v_mfma_f32_16x16x32_bf16 v[196:199], v[80:83], a[212:215], v[196:199]
  s_waitcnt lgkmcnt(4)
  v_mfma_f32_32x32x16_bf16 v[96:111], a[224:227], a[216:219], v[96:111]
  ds_read_b64_tr_b16 a[240:241], v31 offset:16384
  ds_read_b64_tr_b16 a[242:243], v31 offset:16896
  v_mfma_f32_32x32x16_bf16 v[112:127], a[224:227], a[220:223], v[112:127]
  ds_read_b64_tr_b16 a[244:245], v33 offset:16384
  ds_read_b64_tr_b16 a[246:247], v33 offset:16896
  buffer_load_dwordx4 v7, s[16:19], s93 offen offset:1024 lds
  v_mfma_f32_32x32x16_bf16 v[208:223], a[208:211], a[208:211], v[208:223]
  buffer_load_dwordx4 v8, s[16:19], s93 offen offset:2048 lds
  v_mfma_f32_32x32x16_bf16 v[224:239], a[212:215], a[212:215], v[224:239]
  buffer_load_dwordx4 v9, s[16:19], s93 offen offset:3072 lds
  s_waitcnt lgkmcnt(4)
  v_mfma_f32_32x32x16_bf16 v[128:143], a[232:235], a[64:67], 0
  ds_read_b64_tr_b16 a[224:225], v30 offset:20480
  ds_read_b64_tr_b16 a[226:227], v30 offset:20992
  s_mov_b32 s72, 0x07060302
  v_lshlrev_b32 v63, 2, v51
  v_sub_u32_e64 v63, v53, v63
  s_lshl_b32 s57, s3, 11
  v_mfma_f32_32x32x16_bf16 v[144:159], a[232:235], a[68:71], 0
  ds_read_b64_tr_b16 a[228:229], v32 offset:20480
  ds_read_b64_tr_b16 a[230:231], v32 offset:20992
  v_add_u32_e64 v248, s57, v50
  v_add_u32 v248, 147456, v248
  v_xor_b32 v249, 0x1000, v248
  v_xor_b32 v250, 0x800, v248
  v_mfma_f32_32x32x16_bf16 v[160:175], a[236:239], a[64:67], 0
  s_add_u32 m0, s56, 65536
  s_mul_i32 s93, s49, s55
  s_add_u32 s93, s93, s90
  buffer_load_dwordx4 v6, s[16:19], s93 offen offset:0 lds
  v_mfma_f32_32x32x16_bf16 v[176:191], a[236:239], a[68:71], 0
  buffer_load_dwordx4 v7, s[16:19], s93 offen offset:1024 lds
  v_mov_b32 v202, 0
  v_mov_b32 v203, 0
  v_mov_b32_e64 v200, v192
  v_mfma_f32_16x16x32_bf16 v[84:87], v[80:83], a[232:235], 0
  v_mov_b32_e64 v201, v196
  ds_write_b32 v248, v92 offset:1024
  v_mfma_f32_16x16x32_bf16 v[88:91], v[80:83], a[236:239], 0
  v_cmp_eq_u32 s[74:75], 0, v63
  s_waitcnt lgkmcnt(5)
  v_mfma_f32_32x32x16_bf16 v[128:143], a[240:243], a[72:75], v[128:143]
  ds_read_b64_tr_b16 a[232:233], v31 offset:20480
  ds_read_b64_tr_b16 a[234:235], v31 offset:20992
  v_cmp_eq_u32 s[76:77], 1, v63
  s_nop 0
  v_cndmask_b32 v202, v202, v208, s[74:75]
  v_cndmask_b32 v203, v203, v224, s[74:75]
  v_mfma_f32_32x32x16_bf16 v[144:159], a[240:243], a[76:79], v[144:159]
  ds_read_b64_tr_b16 a[236:237], v33 offset:20480
  ds_read_b64_tr_b16 a[238:239], v33 offset:20992
  v_cndmask_b32 v202, v202, v209, s[76:77]
  v_cndmask_b32 v203, v203, v225, s[76:77]
  v_cmp_eq_u32 s[74:75], 2, v63
  v_cmp_eq_u32 s[76:77], 3, v63
  v_mfma_f32_32x32x16_bf16 v[160:175], a[244:247], a[72:75], v[160:175]
  buffer_load_dwordx4 v8, s[16:19], s93 offen offset:2048 lds
  s_nop 0
  v_cndmask_b32 v202, v202, v210, s[74:75]
  v_cndmask_b32 v203, v203, v226, s[74:75]
  v_mfma_f32_32x32x16_bf16 v[176:191], a[244:247], a[76:79], v[176:191]
  v_cndmask_b32 v202, v202, v211, s[76:77]
  v_cndmask_b32 v203, v203, v227, s[76:77]
  v_cmp_eq_u32 s[74:75], 8, v63
  v_cmp_eq_u32 s[76:77], 9, v63
  s_nop 0
  s_waitcnt lgkmcnt(5)
  v_mfma_f32_32x32x16_bf16 v[128:143], a[224:227], a[80:83], v[128:143]
  s_waitcnt vmcnt(19)
  s_barrier
  ds_read_b64_tr_b16 a[240:241], v30 offset:49152
  ds_read_b64_tr_b16 a[242:243], v30 offset:49664
  v_cndmask_b32 v202, v202, v212, s[74:75]
  v_cndmask_b32 v203, v203, v228, s[74:75]
  v_mfma_f32_32x32x16_bf16 v[144:159], a[224:227], a[84:87], v[144:159]
  ds_read_b64_tr_b16 a[244:245], v32 offset:49152
  ds_read_b64_tr_b16 a[246:247], v32 offset:49664
  v_cndmask_b32 v202, v202, v213, s[76:77]
  v_cndmask_b32 v203, v203, v229, s[76:77]
  v_cmp_eq_u32 s[74:75], 10, v63
  v_cmp_eq_u32 s[76:77], 11, v63
  v_mfma_f32_32x32x16_bf16 v[160:175], a[228:231], a[80:83], v[160:175]
  buffer_load_dwordx4 v9, s[16:19], s93 offen offset:3072 lds
  s_nop 0
  v_cndmask_b32 v202, v202, v214, s[74:75]
  v_cndmask_b32 v203, v203, v230, s[74:75]
  v_mfma_f32_32x32x16_bf16 v[176:191], a[228:231], a[84:87], v[176:191]
  s_add_u32 m0, s56, 32768
  s_mul_i32 s93, s50, 229376
  s_add_u32 s93, s93, s0
  buffer_load_dwordx4 v14, s[24:27], s93 offen offset:0 lds
  v_mfma_f32_16x16x32_bf16 v[84:87], v[80:83], a[224:227], v[84:87]
  v_cndmask_b32 v202, v202, v215, s[76:77]
  v_cndmask_b32 v203, v203, v231, s[76:77]
  v_mfma_f32_16x16x32_bf16 v[88:91], v[80:83], a[228:231], v[88:91]
  v_cmp_eq_u32 s[74:75], 16, v63
  s_waitcnt lgkmcnt(4)
  v_mfma_f32_32x32x16_bf16 v[128:143], a[232:235], a[88:91], v[128:143]
  ds_read_b64_tr_b16 a[224:225], v31 offset:49152
  ds_read_b64_tr_b16 a[226:227], v31 offset:49664
  v_cmp_eq_u32 s[76:77], 17, v63
  s_nop 0
  v_cndmask_b32 v202, v202, v216, s[74:75]
  v_cndmask_b32 v203, v203, v232, s[74:75]
  v_mfma_f32_32x32x16_bf16 v[144:159], a[232:235], a[92:95], v[144:159]
  ds_read_b64_tr_b16 a[228:229], v33 offset:49152
  ds_read_b64_tr_b16 a[230:231], v33 offset:49664
  v_cndmask_b32 v202, v202, v217, s[76:77]
  v_cndmask_b32 v203, v203, v233, s[76:77]
  v_cmp_eq_u32 s[74:75], 18, v63
  v_cmp_eq_u32 s[76:77], 19, v63
  v_mfma_f32_32x32x16_bf16 v[160:175], a[236:239], a[88:91], v[160:175]
  buffer_load_dwordx4 v15, s[24:27], s93 offen offset:1024 lds
  s_nop 0
  v_cndmask_b32 v202, v202, v218, s[74:75]
  v_cndmask_b32 v203, v203, v234, s[74:75]
  v_mfma_f32_32x32x16_bf16 v[176:191], a[236:239], a[92:95], v[176:191]
  v_cndmask_b32 v202, v202, v219, s[76:77]
  v_cndmask_b32 v203, v203, v235, s[76:77]
  v_cmp_eq_u32 s[74:75], 24, v63
  v_cmp_eq_u32 s[76:77], 25, v63
  s_nop 0
  s_waitcnt lgkmcnt(4)
  v_mfma_f32_32x32x16_bf16 v[128:143], a[240:243], a[96:99], v[128:143]
  ds_read_b64_tr_b16 a[232:233], v30 offset:53248
  ds_read_b64_tr_b16 a[234:235], v30 offset:53760
  v_cndmask_b32 v202, v202, v220, s[74:75]
  v_cndmask_b32 v203, v203, v236, s[74:75]
  v_cndmask_b32 v202, v202, v221, s[76:77]
  v_cndmask_b32 v203, v203, v237, s[76:77]
  v_mfma_f32_32x32x16_bf16 v[144:159], a[240:243], a[100:103], v[144:159]
  ds_read_b64_tr_b16 a[236:237], v32 offset:53248
  ds_read_b64_tr_b16 a[238:239], v32 offset:53760
  v_cmp_eq_u32 s[74:75], 26, v63
  v_cmp_eq_u32 s[76:77], 27, v63
  s_nop 0
  v_cndmask_b32 v202, v202, v222, s[74:75]
  v_mfma_f32_32x32x16_bf16 v[160:175], a[244:247], a[96:99], v[160:175]
  buffer_load_dwordx4 v16, s[24:27], s93 offen offset:2048 lds
  v_cndmask_b32 v203, v203, v238, s[74:75]
  v_cndmask_b32 v202, v202, v223, s[76:77]
  v_cndmask_b32 v203, v203, v239, s[76:77]
  v_mfma_f32_32x32x16_bf16 v[176:191], a[244:247], a[100:103], v[176:191]
  buffer_load_dwordx4 v17, s[24:27], s93 offen offset:3072 lds
  ds_write_b128 v248, v[200:203]
  v_mfma_f32_16x16x32_bf16 v[84:87], v[80:83], a[240:243], v[84:87]
  v_mfma_f32_16x16x32_bf16 v[88:91], v[80:83], a[244:247], v[88:91]
  s_waitcnt lgkmcnt(5)
  v_mfma_f32_32x32x16_bf16 v[128:143], a[224:227], a[104:107], v[128:143]
  ds_read_b64_tr_b16 a[240:241], v31 offset:53248
  ds_read_b64_tr_b16 a[242:243], v31 offset:53760
  v_mfma_f32_32x32x16_bf16 v[144:159], a[224:227], a[108:111], v[144:159]
  ds_read_b64_tr_b16 a[244:245], v33 offset:53248
  ds_read_b64_tr_b16 a[246:247], v33 offset:53760
  v_mfma_f32_32x32x16_bf16 v[160:175], a[228:231], a[104:107], v[160:175]
  s_add_u32 m0, s56, 0
  s_mul_i32 s93, s51, 229376
  s_add_u32 s93, s93, s0
  buffer_load_dwordx4 v14, s[24:27], s93 offen offset:0 lds
  v_mfma_f32_32x32x16_bf16 v[176:191], a[228:231], a[108:111], v[176:191]
  s_waitcnt lgkmcnt(5)
  v_mfma_f32_32x32x16_bf16 v[128:143], a[232:235], a[112:115], v[128:143]
  s_waitcnt lgkmcnt(4)
  s_waitcnt vmcnt(21)
  s_barrier
  ds_read_b64_tr_b16 a[224:225], v38 offset:0
  ds_read_b64_tr_b16 a[226:227], v38 offset:512
  ds_read_b128 v[204:207], v249
  ds_read_b32 v240, v250 offset:1024
  v_mfma_f32_32x32x16_bf16 v[144:159], a[232:235], a[116:119], v[144:159]
  ds_read_b64_tr_b16 a[228:229], v40 offset:0
  ds_read_b64_tr_b16 a[230:231], v40 offset:512
  v_cmp_eq_u32 s[74:75], 0, v51
  s_lshl2_add_u32 s76, s89, s7
  s_mul_i32 s76, s76, 66560
  s_add_u32 s76, s76, 65536
  v_mfma_f32_32x32x16_bf16 v[160:175], a[236:239], a[112:115], v[160:175]
  buffer_load_dwordx4 v15, s[24:27], s93 offen offset:1024 lds
  s_add_u32 s77, s76, 133120
  s_waitcnt lgkmcnt(2)
  v_add_f32_e64 v200, v200, v204
  v_mfma_f32_32x32x16_bf16 v[176:191], a[236:239], a[116:119], v[176:191]
  buffer_load_dwordx4 v16, s[24:27], s93 offen offset:2048 lds
  v_add_f32 v201, v201, v205
  v_add_f32 v202, v202, v206
  v_add_f32_e64 v203, v203, v207
  v_mfma_f32_16x16x32_bf16 v[84:87], v[80:83], a[232:235], v[84:87]
  v_cndmask_b32 v240, v240, v92, s[74:75]
  v_mov_b32_e64 v204, v202
  v_mfma_f32_16x16x32_bf16 v[88:91], v[80:83], a[236:239], v[88:91]
  v_mov_b32_e64 v205, v203
  v_mfma_f32_32x32x16_bf16 v[128:143], a[240:243], a[120:123], v[128:143]
  ds_read_b64_tr_b16 a[232:233], v39 offset:0
  ds_read_b64_tr_b16 a[234:235], v39 offset:512
  v_mul_f32 v200, 0x3b124925, v200
  v_mul_f32 v201, 0x3b124925, v201
  v_permlane32_swap_b32 v204, v202
  v_permlane32_swap_b32 v205, v203
  v_mfma_f32_32x32x16_bf16 v[144:159], a[240:243], a[124:127], v[144:159]
  ds_read_b64_tr_b16 a[236:237], v41 offset:0
  ds_read_b64_tr_b16 a[238:239], v41 offset:512
  v_cvt_pk_bf16_f32 v18, -v200, -v200
  v_add_f32_e64 v202, v202, v204
  v_cvt_pk_bf16_f32 v22, -v201, -v201
  v_add_f32_e64 v203, v203, v205
  v_mfma_f32_32x32x16_bf16 v[160:175], a[244:247], a[120:123], v[160:175]
  buffer_load_dwordx4 v17, s[24:27], s93 offen offset:3072 lds
  v_mov_b32 v19, v18
  v_mov_b32 v20, v18
  v_mov_b32_e64 v21, v18
  v_mfma_f32_32x32x16_bf16 v[176:191], a[244:247], a[124:127], v[176:191]
  v_mov_b32 v23, v22
  v_mov_b32 v24, v22
  v_mov_b32_e64 v25, v22
  v_and_b32 v244, 0xffff0000, v240
  v_sub_f32 v244, v240, v244
  s_waitcnt lgkmcnt(4)
  v_mfma_f32_32x32x16_bf16 v[128:143], a[224:227], a[128:131], v[128:143]
  ds_read_b64_tr_b16 a[240:241], v38 offset:4096
  ds_read_b64_tr_b16 a[242:243], v38 offset:4608
  v_perm_b32 v92, v244, v240, s72
  v_and_b32 v93, 0xffff0000, v244
  v_sub_f32 v244, v244, v93
  v_lshrrev_b32 v93, 16, v244
  v_mfma_f32_32x32x16_bf16 v[144:159], a[224:227], a[132:135], v[144:159]
  ds_read_b64_tr_b16 a[244:245], v40 offset:4096
  ds_read_b64_tr_b16 a[246:247], v40 offset:4608
  v_mov_b32 v94, 0
  v_mov_b32 v95, 0
  v_mfma_f32_32x32x16_bf16 v[160:175], a[228:231], a[128:131], v[160:175]
  s_add_u32 m0, s56, 16384
  s_mul_i32 s93, s52, 229376
  s_add_u32 s93, s93, s0
  buffer_load_dwordx4 v14, s[24:27], s93 offen offset:0 lds
  v_mfma_f32_32x32x16_bf16 v[176:191], a[228:231], a[132:135], v[176:191]
  buffer_load_dwordx4 v15, s[24:27], s93 offen offset:1024 lds
  v_mfma_f32_32x32x16_bf16 v[96:111], v[92:95], v[18:21], v[96:111]
  v_mul_f32 v202, 0x3b124925, v202
  v_mul_f32 v203, 0x3b124925, v203
  v_fma_f32 v202, -v200, v200, v202
  v_fma_f32 v203, -v201, v201, v203
  v_max_f32 v202, 0, v202
  v_mfma_f32_16x16x32_bf16 v[84:87], v[80:83], a[224:227], v[84:87]
  v_mfma_f32_16x16x32_bf16 v[88:91], v[80:83], a[228:231], v[88:91]
  s_waitcnt lgkmcnt(4)
  v_mfma_f32_32x32x16_bf16 v[128:143], a[232:235], a[136:139], v[128:143]
  ds_read_b64_tr_b16 a[224:225], v39 offset:4096
  ds_read_b64_tr_b16 a[226:227], v39 offset:4608
  v_mfma_f32_32x32x16_bf16 v[112:127], v[92:95], v[22:25], v[112:127]
  v_max_f32 v203, 0, v203
  v_cvt_pk_bf16_f32 v202, v202, v202
  v_cvt_pk_bf16_f32 v203, v203, v203
  v_and_b32 v202, 0xffff0000, v202
  v_and_b32 v203, 0xffff0000, v203
  v_mfma_f32_32x32x16_bf16 v[144:159], a[232:235], a[140:143], v[144:159]
  ds_read_b64_tr_b16 a[228:229], v41 offset:4096
  ds_read_b64_tr_b16 a[230:231], v41 offset:4608
  v_add_f32 v202, 0x3727c5ac, v202
  v_add_f32 v203, 0x3727c5ac, v203
  v_cvt_pk_bf16_f32 v202, v202, v202
  v_cvt_pk_bf16_f32 v203, v203, v203
  v_mfma_f32_32x32x16_bf16 v[160:175], a[236:239], a[136:139], v[160:175]
  buffer_load_dwordx4 v16, s[24:27], s93 offen offset:2048 lds
  v_and_b32 v202, 0xffff0000, v202
  v_and_b32 v203, 0xffff0000, v203
  v_mfma_f32_32x32x16_bf16 v[176:191], a[236:239], a[140:143], v[176:191]
  v_sqrt_f32 v202, v202
  v_sqrt_f32 v203, v203
  v_cvt_pk_bf16_f32 v202, v202, v202
  s_waitcnt lgkmcnt(4)
  v_mfma_f32_32x32x16_bf16 v[128:143], a[240:243], a[144:147], v[128:143]
  s_waitcnt vmcnt(23)
  s_barrier
  ds_read_b64_tr_b16 a[232:233], v34 offset:49152
  ds_read_b64_tr_b16 a[234:235], v34 offset:49664
  v_cvt_pk_bf16_f32 v203, v203, v203
  v_and_b32 v202, 0xffff0000, v202
  v_mfma_f32_32x32x16_bf16 v[144:159], a[240:243], a[148:151], v[144:159]
  ds_read_b64_tr_b16 a[236:237], v36 offset:49152
  ds_read_b64_tr_b16 a[238:239], v36 offset:49664
  v_and_b32 v203, 0xffff0000, v203
  v_rcp_f32 v60, v202
  v_mfma_f32_32x32x16_bf16 v[160:175], a[244:247], a[144:147], v[160:175]
  buffer_load_dwordx4 v17, s[24:27], s93 offen offset:3072 lds
  v_rcp_f32 v61, v203
  v_mul_f32 v58, v202, v202
  v_mfma_f32_32x32x16_bf16 v[176:191], a[244:247], a[148:151], v[176:191]
  s_add_u32 m0, s56, 49152
  s_mul_i32 s93, s53, 229376
  s_add_u32 s93, s93, s0
  buffer_load_dwordx4 v14, s[24:27], s93 offen offset:0 lds
  v_mfma_f32_16x16x32_bf16 v[84:87], v[80:83], a[240:243], v[84:87]
  v_mul_f32 v59, v203, v203
  v_mul_f32 v54, 0xc0135761, v60
  v_mfma_f32_16x16x32_bf16 v[88:91], v[80:83], a[244:247], v[88:91]
  v_mul_f32 v55, 0xc0135761, v61
  s_waitcnt lgkmcnt(4)
  v_mfma_f32_32x32x16_bf16 v[128:143], a[224:227], a[152:155], v[128:143]
  ds_read_b64_tr_b16 a[240:241], v35 offset:49152
  ds_read_b64_tr_b16 a[242:243], v35 offset:49664
  v_mul_f32 v56, v60, v60
  v_mul_f32 v57, v61, v61
  v_mul_f32 v56, v56, v54
  v_mul_f32_e64 v57, v57, v55
  v_mfma_f32_32x32x16_bf16 v[144:159], a[224:227], a[156:159], v[144:159]
  ds_read_b64_tr_b16 a[244:245], v37 offset:49152
  ds_read_b64_tr_b16 a[246:247], v37 offset:49664
  v_mul_f32 v56, 0x3d372713, v56
  v_mul_f32 v57, 0x3d372713, v57
  v_mul_f32 v96, v96, v60
  v_mul_f32 v97, v97, v60
  v_mfma_f32_32x32x16_bf16 v[160:175], a[228:231], a[152:155], v[160:175]
  buffer_load_dwordx4 v15, s[24:27], s93 offen offset:1024 lds
  v_mul_f32 v98, v98, v60
  v_mul_f32 v99, v99, v60
  v_mul_f32_e64 v100, v100, v60
  v_mfma_f32_32x32x16_bf16 v[176:191], a[228:231], a[156:159], v[176:191]
  v_mul_f32 v101, v101, v60
  v_mul_f32 v102, v102, v60
  v_mul_f32 v103, v103, v60
  v_mul_f32 v104, v104, v60
  v_mul_f32 v105, v105, v60
  s_waitcnt lgkmcnt(4)
  v_mfma_f32_32x32x16_bf16 v[128:143], a[232:235], a[160:163], v[128:143]
  ds_read_b64_tr_b16 a[224:225], v34 offset:53248
  ds_read_b64_tr_b16 a[226:227], v34 offset:53760
  v_mul_f32 v106, v106, v60
  v_mul_f32 v107, v107, v60
  v_mul_f32 v108, v108, v60
  v_mul_f32 v109, v109, v60
  v_mfma_f32_32x32x16_bf16 v[144:159], a[232:235], a[164:167], v[144:159]
  ds_read_b64_tr_b16 a[228:229], v36 offset:53248
  ds_read_b64_tr_b16 a[230:231], v36 offset:53760
  v_mul_f32 v110, v110, v60
  v_mul_f32 v111, v111, v60
  v_cvt_pk_bf16_f32 v96, v96, v97
  v_cvt_pk_bf16_f32 v97, v98, v99
  v_mfma_f32_32x32x16_bf16 v[160:175], a[236:239], a[160:163], v[160:175]
  buffer_load_dwordx4 v16, s[24:27], s93 offen offset:2048 lds
  v_cvt_pk_bf16_f32 v98, v100, v101
  v_cvt_pk_bf16_f32 v99, v102, v103
  v_cvt_pk_bf16_f32 v100, v104, v105
  v_mfma_f32_32x32x16_bf16 v[176:191], a[236:239], a[164:167], v[176:191]
  buffer_load_dwordx4 v17, s[24:27], s93 offen offset:3072 lds
  v_cvt_pk_bf16_f32 v101, v106, v107
  v_cvt_pk_bf16_f32 v102, v108, v109
  v_cvt_pk_bf16_f32 v103, v110, v111
  v_mfma_f32_16x16x32_bf16 v[84:87], v[80:83], a[232:235], v[84:87]
  v_mfma_f32_16x16x32_bf16 v[88:91], v[80:83], a[236:239], v[88:91]
  s_waitcnt lgkmcnt(4)
  v_mfma_f32_32x32x16_bf16 v[128:143], a[240:243], a[168:171], v[128:143]
  ds_read_b64_tr_b16 a[232:233], v35 offset:53248
  ds_read_b64_tr_b16 a[234:235], v35 offset:53760
  buffer_store_dwordx2 v[96:97], v49, s[84:87], s76 offen offset:0 sc1
  v_mfma_f32_32x32x16_bf16 v[144:159], a[240:243], a[172:175], v[144:159]
  ds_read_b64_tr_b16 a[236:237], v37 offset:53248
  ds_read_b64_tr_b16 a[238:239], v37 offset:53760
  s_add_u32 s78, s76, 33280
  buffer_store_dwordx2 v[98:99], v49, s[84:87], s78 offen offset:0 sc1
  v_mfma_f32_32x32x16_bf16 v[160:175], a[244:247], a[168:171], v[160:175]
  buffer_store_dwordx2 v[100:101], v49, s[84:87], s77 offen offset:0 sc1
  v_mfma_f32_32x32x16_bf16 v[176:191], a[244:247], a[172:175], v[176:191]
  s_add_u32 s78, s77, 33280
  buffer_store_dwordx2 v[102:103], v49, s[84:87], s78 offen offset:0 sc1
  v_mul_f32_e64 v112, v112, v61
  s_waitcnt lgkmcnt(4)
  v_mfma_f32_32x32x16_bf16 v[128:143], a[224:227], a[176:179], v[128:143]
  s_waitcnt vmcnt(28)
  s_barrier
  ds_read_b64_tr_b16 a[240:241], v34 offset:32768
  ds_read_b64_tr_b16 a[242:243], v34 offset:33280
  v_mul_f32 v113, v113, v61
  v_mul_f32 v114, v114, v61
  v_mfma_f32_32x32x16_bf16 v[144:159], a[224:227], a[180:183], v[144:159]
  ds_read_b64_tr_b16 a[244:245], v36 offset:32768
  ds_read_b64_tr_b16 a[246:247], v36 offset:33280
  v_mul_f32 v115, v115, v61
  v_mul_f32 v116, v116, v61
  v_mul_f32 v117, v117, v61
  v_mul_f32 v118, v118, v61
  v_mfma_f32_32x32x16_bf16 v[160:175], a[228:231], a[176:179], v[160:175]
  v_mov_b32 v68, 1
  v_and_b32 v73, 15, v1
  v_lshlrev_b32_e64 v73, 4, v73
  s_cmp_lg_u32 s3, 0
  s_cbranch_scc1 L_db_5
  buffer_load_dword v68, v73, s[32:35], 0 offen sc1
L_db_5:
  v_mfma_f32_32x32x16_bf16 v[176:191], a[228:231], a[180:183], v[176:191]
  v_mul_f32 v119, v119, v61
  v_mul_f32 v120, v120, v61
  v_mul_f32 v121, v121, v61
  v_mul_f32 v122, v122, v61
  v_mul_f32 v123, v123, v61
  v_mul_f32 v124, v124, v61
  v_mfma_f32_16x16x32_bf16 v[84:87], v[80:83], a[224:227], v[84:87]
  v_mul_f32 v125, v125, v61
  v_mul_f32 v126, v126, v61
  v_mfma_f32_16x16x32_bf16 v[88:91], v[80:83], a[228:231], v[88:91]
  v_mul_f32 v127, v127, v61
  s_waitcnt lgkmcnt(4)
  v_mfma_f32_32x32x16_bf16 v[128:143], a[232:235], a[184:187], v[128:143]
  ds_read_b64_tr_b16 a[224:225], v35 offset:32768
  ds_read_b64_tr_b16 a[226:227], v35 offset:33280
  v_cvt_pk_bf16_f32 v112, v112, v113
  v_cvt_pk_bf16_f32 v113, v114, v115
  v_cvt_pk_bf16_f32 v114, v116, v117
  v_cvt_pk_bf16_f32 v115, v118, v119
  v_mfma_f32_32x32x16_bf16 v[144:159], a[232:235], a[188:191], v[144:159]
  ds_read_b64_tr_b16 a[228:229], v37 offset:32768
  ds_read_b64_tr_b16 a[230:231], v37 offset:33280
  v_cvt_pk_bf16_f32 v116, v120, v121
  v_cvt_pk_bf16_f32 v117, v122, v123
  v_cvt_pk_bf16_f32 v118, v124, v125
  v_cvt_pk_bf16_f32 v119, v126, v127
  v_mfma_f32_32x32x16_bf16 v[160:175], a[236:239], a[184:187], v[160:175]
  buffer_store_dwordx2 v[112:113], v49, s[84:87], s76 offen offset:256 sc1
  v_mfma_f32_32x32x16_bf16 v[176:191], a[236:239], a[188:191], v[176:191]
  s_add_u32 s78, s76, 33280
  buffer_store_dwordx2 v[114:115], v49, s[84:87], s78 offen offset:256 sc1
  s_waitcnt lgkmcnt(4)
  v_mfma_f32_32x32x16_bf16 v[128:143], a[240:243], a[192:195], v[128:143]
  ds_read_b64_tr_b16 a[232:233], v34 offset:36864
  ds_read_b64_tr_b16 a[234:235], v34 offset:37376
  buffer_store_dwordx2 v[116:117], v49, s[84:87], s77 offen offset:256 sc1
  v_mfma_f32_32x32x16_bf16 v[144:159], a[240:243], a[196:199], v[144:159]
  ds_read_b64_tr_b16 a[236:237], v36 offset:36864
  ds_read_b64_tr_b16 a[238:239], v36 offset:37376
  s_add_u32 s78, s77, 33280
  buffer_store_dwordx2 v[118:119], v49, s[84:87], s78 offen offset:256 sc1
  v_mfma_f32_32x32x16_bf16 v[160:175], a[244:247], a[192:195], v[160:175]
  s_lshl1_add_u32 s57, s4, s6
  s_mul_i32 s57, s57, 112
  s_lshl1_add_u32 s58, s62, s7
  s_add_u32 s57, s57, s58
  s_lshl_b32 s57, s57, 11
  s_add_u32 s96, s57, 8388608
  v_mfma_f32_32x32x16_bf16 v[176:191], a[244:247], a[196:199], v[176:191]
  s_add_u32 s97, s96, 114688
  s_lshl1_add_u32 s57, s70, s6
  s_mul_i32 s57, s57, 28672
  s_lshl1_add_u32 s58, s71, s7
  s_lshl_b32 s58, s58, 6
  s_add_u32 s57, s57, s58
  v_mfma_f32_16x16x32_bf16 v[84:87], v[80:83], a[240:243], v[84:87]
  v_mul_u32_u24 v65, 896, v53
  v_add_u32 v65, s57, v65
  v_mfma_f32_16x16x32_bf16 v[88:91], v[80:83], a[244:247], v[88:91]
  v_lshl_add_u32 v13, v51, 4, v65
  s_waitcnt lgkmcnt(4)
  v_mfma_f32_32x32x16_bf16 v[128:143], a[224:227], a[200:203], v[128:143]
  ds_read_b64_tr_b16 a[240:241], v35 offset:36864
  ds_read_b64_tr_b16 a[242:243], v35 offset:37376
  buffer_load_dwordx4 a[248:251], v13, s[8:11], 0 offen
  s_add_u32 s57, s4, 0
  v_mfma_f32_32x32x16_bf16 v[144:159], a[224:227], a[204:207], v[144:159]
  ds_read_b64_tr_b16 a[244:245], v37 offset:36864
  ds_read_b64_tr_b16 a[246:247], v37 offset:37376
  s_cmp_ge_u32 s57, 2
  s_cselect_b32 s57, 0, 1073741808
  v_add_u32_e64 v10, s57, v50
  s_add_u32 s57, s4, 1
  v_mfma_f32_32x32x16_bf16 v[160:175], a[228:231], a[200:203], v[160:175]
  s_cmp_ge_u32 s57, 2
  s_cselect_b32 s57, 0, 1073741808
  v_add_u32 v11, s57, v50
  s_add_u32 s57, s4, 2
  s_cmp_ge_u32 s57, 2
  s_cselect_b32 s57, 0, 1073741808
  v_mfma_f32_32x32x16_bf16 v[176:191], a[228:231], a[204:207], v[176:191]
  v_add_u32 v12, s57, v50
  s_lshr_b32 s57, s5, 2
  s_lshl_b32 s57, s57, 7
  s_and_b32 s58, s5, 3
  s_lshl1_add_u32 s57, s58, s57
  s_waitcnt lgkmcnt(4)
  v_mfma_f32_32x32x16_bf16 v[128:143], a[232:235], a[208:211], v[128:143]
  s_waitcnt vmcnt(29)
  s_barrier
  ds_read_b64_tr_b16 a[224:225], v34 offset:16384
  ds_read_b64_tr_b16 a[226:227], v34 offset:16896
  s_lshl_b32 s58, s4, 15
  s_add_u32 s57, s57, s58
  v_mfma_f32_32x32x16_bf16 v[144:159], a[232:235], a[212:215], v[144:159]
  ds_read_b64_tr_b16 a[228:229], v36 offset:16384
  ds_read_b64_tr_b16 a[230:231], v36 offset:16896
  s_add_u32 s57, s57, 16254208
  s_lshl_b32 s58, s6, 14
  s_add_u32 s58, s58, s7
  s_add_u32 s58, s58, s57
  v_mfma_f32_32x32x16_bf16 v[160:175], a[236:239], a[208:211], v[160:175]
  s_lshl_b32 s59, s7, 14
  s_add_u32 s59, s59, s6
  s_add_u32 s59, s59, s57
  s_add_u32 s59, s59, 8
  v_cmp_gt_u32 s[74:75], 7, v1
  v_lshl_add_u32 v65, v1, 11, s58
  v_mfma_f32_32x32x16_bf16 v[176:191], a[236:239], a[212:215], v[176:191]
  v_lshl_add_u32 v66, v1, 11, s59
  v_cndmask_b32 v94, v78, v65, s[74:75]
  v_cndmask_b32 v95, v78, v66, s[74:75]
  s_lshl_b32 s57, s3, 8
  v_mul_u32_u24 v65, 6144, v51
  v_lshl_add_u32 v65, v53, 3, v65
  v_mfma_f32_16x16x32_bf16 v[84:87], v[80:83], a[232:235], v[84:87]
  v_add_u32_e64 v65, s57, v65
  v_add_u32 v42, 114688, v65
  v_mfma_f32_16x16x32_bf16 v[88:91], v[80:83], a[236:239], v[88:91]
  v_bfe_u32 v65, v1, 4, 1
  s_waitcnt lgkmcnt(4)
  v_mfma_f32_32x32x16_bf16 v[128:143], a[240:243], a[216:219], v[128:143]
  ds_read_b64_tr_b16 a[232:233], v35 offset:16384
  ds_read_b64_tr_b16 a[234:235], v35 offset:16896
  v_and_b32 v66, 3, v1
  v_lshl_add_u32 v65, v65, 2, v66
  v_mul_u32_u24 v66, 3104, v65
  v_mfma_f32_32x32x16_bf16 v[144:159], a[240:243], a[220:223], v[144:159]
  ds_read_b64_tr_b16 a[236:237], v37 offset:16384
  ds_read_b64_tr_b16 a[238:239], v37 offset:16896
  buffer_load_dwordx4 a[252:255], v13, s[8:11], 0 offen offset:32
  v_mov_b32_e64 v67, s57
  v_mfma_f32_32x32x16_bf16 v[160:175], a[244:247], a[216:219], v[160:175]
  v_cmp_ne_u32 s[74:75], 7, v65
  v_bfe_u32 v65, v1, 2, 2
  v_lshl_add_u32 v65, v51, 2, v65
  v_cndmask_b32 v67, 0, v67, s[74:75]
  v_lshl_add_u32 v66, v65, 3, v66
  v_add_u32_e64 v43, v66, v67
  v_mfma_f32_32x32x16_bf16 v[176:191], a[244:247], a[220:223], v[176:191]
  v_add_u32 v43, 139264, v43
  v_lshlrev_b32 v65, 7, v65
  v_and_b32 v66, 3, v1
  v_lshl_add_u32 v65, v66, 3, v65
  v_bfe_u32 v66, v1, 3, 1
  s_waitcnt lgkmcnt(4)
  v_mfma_f32_32x32x16_bf16 v[128:143], a[224:227], a[0:3], v[128:143]
  ds_read_b64_tr_b16 a[240:241], v34 offset:20480
  ds_read_b64_tr_b16 a[242:243], v34 offset:20992
  v_bfe_u32 v67, v1, 4, 1
  v_lshl_or_b32 v66, v66, 1, v67
  s_lshl_b32 s58, s7, 1
  v_xor_b32_e64 v66, s58, v66
  v_mfma_f32_32x32x16_bf16 v[144:159], a[224:227], a[4:7], v[144:159]
  ds_read_b64_tr_b16 a[244:245], v36 offset:20480
  ds_read_b64_tr_b16 a[246:247], v36 offset:20992
  v_xor_b32_e64 v67, 0, v66
  v_lshl_add_u32 v92, v67, 5, v65
  v_add_u32_e64 v44, s56, v92
  v_add_u32 v46, 0x10000, v44
  v_mfma_f32_32x32x16_bf16 v[160:175], a[228:231], a[0:3], v[160:175]
  v_xor_b32_e64 v67, 2, v66
  v_lshl_add_u32 v93, v67, 5, v65
  v_add_u32_e64 v45, s56, v93
  v_add_u32 v47, 0x10000, v45
  v_lshlrev_b32 v65, 2, v51
  v_sub_u32 v65, v53, v65
  v_mfma_f32_32x32x16_bf16 v[176:191], a[228:231], a[4:7], v[176:191]
  v_mov_b32 v66, 0xf149f2ca
  v_cmp_gt_i32 s[74:75], 0, v65
  v_cmp_gt_i32 s[76:77], 1, v65
  s_nop 0
  v_cndmask_b32 v96, v66, 0, s[74:75]
  v_cndmask_b32 v112, 0, v66, s[74:75]
  v_mfma_f32_16x16x32_bf16 v[84:87], v[80:83], a[224:227], v[84:87]
  v_cndmask_b32 v97, v66, 0, s[76:77]
  v_cndmask_b32 v113, 0, v66, s[76:77]
  v_mfma_f32_16x16x32_bf16 v[88:91], v[80:83], a[228:231], v[88:91]
  v_cmp_gt_i32 s[74:75], 2, v65
  s_waitcnt lgkmcnt(4)
  v_mfma_f32_32x32x16_bf16 v[128:143], a[232:235], a[8:11], v[128:143]
  ds_read_b64_tr_b16 a[224:225], v35 offset:20480
  ds_read_b64_tr_b16 a[226:227], v35 offset:20992
  v_cmp_gt_i32 s[76:77], 3, v65
  s_nop 0
  v_cndmask_b32 v98, v66, 0, s[74:75]
  v_cndmask_b32 v114, 0, v66, s[74:75]
  v_mfma_f32_32x32x16_bf16 v[144:159], a[232:235], a[12:15], v[144:159]
  ds_read_b64_tr_b16 a[228:229], v37 offset:20480
  ds_read_b64_tr_b16 a[230:231], v37 offset:20992
  v_cndmask_b32 v99, v66, 0, s[76:77]
  v_cndmask_b32 v115, 0, v66, s[76:77]
  v_cmp_gt_i32 s[74:75], 8, v65
  v_cmp_gt_i32 s[76:77], 9, v65
  v_mfma_f32_32x32x16_bf16 v[160:175], a[236:239], a[8:11], v[160:175]
  s_nop 0
  v_cndmask_b32 v100, v66, 0, s[74:75]
  v_cndmask_b32 v116, 0, v66, s[74:75]
  v_cndmask_b32 v101, v66, 0, s[76:77]
  v_cndmask_b32 v117, 0, v66, s[76:77]
  v_cmp_gt_i32 s[74:75], 10, v65
  v_mfma_f32_32x32x16_bf16 v[176:191], a[236:239], a[12:15], v[176:191]
  v_cmp_gt_i32 s[76:77], 11, v65
  s_nop 0
  v_cndmask_b32 v102, v66, 0, s[74:75]
  v_cndmask_b32 v118, 0, v66, s[74:75]
  v_cndmask_b32 v103, v66, 0, s[76:77]
  s_waitcnt lgkmcnt(4)
  v_mfma_f32_32x32x16_bf16 v[128:143], a[240:243], a[16:19], v[128:143]
  s_waitcnt vmcnt(26)
  s_barrier
  ds_read_b64_tr_b16 a[232:233], v34 offset:0
  ds_read_b64_tr_b16 a[234:235], v34 offset:512
  v_cndmask_b32 v119, 0, v66, s[76:77]
  v_cmp_gt_i32 s[74:75], 16, v65
  v_mfma_f32_32x32x16_bf16 v[144:159], a[240:243], a[20:23], v[144:159]
  ds_read_b64_tr_b16 a[236:237], v36 offset:0
  ds_read_b64_tr_b16 a[238:239], v36 offset:512
  v_cmp_gt_i32 s[76:77], 17, v65
  s_nop 0
  v_cndmask_b32 v104, v66, 0, s[74:75]
  v_cndmask_b32 v120, 0, v66, s[74:75]
  v_mfma_f32_32x32x16_bf16 v[160:175], a[244:247], a[16:19], v[160:175]
  s_add_u32 m0, s56, 98304
  s_mul_i32 s93, s54, 229376
  s_add_u32 s93, s93, s0
  buffer_load_dwordx4 v14, s[24:27], s93 offen offset:0 lds
  v_mfma_f32_32x32x16_bf16 v[176:191], a[244:247], a[20:23], v[176:191]
  buffer_load_dwordx4 v15, s[24:27], s93 offen offset:1024 lds
  v_cndmask_b32 v105, v66, 0, s[76:77]
  v_cndmask_b32 v121, 0, v66, s[76:77]
  v_cmp_gt_i32 s[74:75], 18, v65
  v_mfma_f32_16x16x32_bf16 v[84:87], v[80:83], a[240:243], v[84:87]
  v_cmp_gt_i32 s[76:77], 19, v65
  s_nop 0
  v_mfma_f32_16x16x32_bf16 v[88:91], v[80:83], a[244:247], v[88:91]
  v_cndmask_b32 v106, v66, 0, s[74:75]
  s_waitcnt lgkmcnt(4)
  v_mfma_f32_32x32x16_bf16 v[128:143], a[224:227], a[24:27], v[128:143]
  ds_read_b64_tr_b16 a[240:241], v35 offset:0
  ds_read_b64_tr_b16 a[242:243], v35 offset:512
  v_cndmask_b32 v122, 0, v66, s[74:75]
  v_cndmask_b32 v107, v66, 0, s[76:77]
  v_cndmask_b32 v123, 0, v66, s[76:77]
  v_cmp_gt_i32 s[74:75], 24, v65
  v_mfma_f32_32x32x16_bf16 v[144:159], a[224:227], a[28:31], v[144:159]
  ds_read_b64_tr_b16 a[244:245], v37 offset:0
  ds_read_b64_tr_b16 a[246:247], v37 offset:512
  v_cmp_gt_i32 s[76:77], 25, v65
  s_nop 0
  v_cndmask_b32 v108, v66, 0, s[74:75]
  v_cndmask_b32 v124, 0, v66, s[74:75]
  v_mfma_f32_32x32x16_bf16 v[160:175], a[228:231], a[24:27], v[160:175]
  buffer_load_dwordx4 v16, s[24:27], s93 offen offset:2048 lds
  v_cndmask_b32 v109, v66, 0, s[76:77]
  v_cndmask_b32 v125, 0, v66, s[76:77]
  v_cmp_gt_i32 s[74:75], 26, v65
  v_mfma_f32_32x32x16_bf16 v[176:191], a[228:231], a[28:31], v[176:191]
  v_cmp_gt_i32 s[76:77], 27, v65
  s_nop 0
  v_cndmask_b32 v110, v66, 0, s[74:75]
  v_cndmask_b32 v126, 0, v66, s[74:75]
  v_cndmask_b32 v111, v66, 0, s[76:77]
  s_waitcnt lgkmcnt(4)
  v_mfma_f32_32x32x16_bf16 v[128:143], a[232:235], a[32:35], v[128:143]
  ds_read_b64_tr_b16 a[224:225], v34 offset:4096
  ds_read_b64_tr_b16 a[226:227], v34 offset:4608
  v_cndmask_b32 v127, 0, v66, s[76:77]
  v_mfma_f32_32x32x16_bf16 v[144:159], a[232:235], a[36:39], v[144:159]
  ds_read_b64_tr_b16 a[228:229], v36 offset:4096
  ds_read_b64_tr_b16 a[230:231], v36 offset:4608
  v_mfma_f32_32x32x16_bf16 v[160:175], a[236:239], a[32:35], v[160:175]
  buffer_load_dwordx4 v17, s[24:27], s93 offen offset:3072 lds
  v_mfma_f32_32x32x16_bf16 v[176:191], a[236:239], a[36:39], v[176:191]
  v_mfma_f32_16x16x32_bf16 v[84:87], v[80:83], a[232:235], v[84:87]
  v_mfma_f32_16x16x32_bf16 v[88:91], v[80:83], a[236:239], v[88:91]
  s_waitcnt lgkmcnt(4)
  v_mfma_f32_32x32x16_bf16 v[128:143], a[240:243], a[40:43], v[128:143]
  ds_read_b64_tr_b16 a[232:233], v35 offset:4096
  ds_read_b64_tr_b16 a[234:235], v35 offset:4608
  v_mfma_f32_32x32x16_bf16 v[144:159], a[240:243], a[44:47], v[144:159]
  ds_read_b64_tr_b16 a[236:237], v37 offset:4096
  ds_read_b64_tr_b16 a[238:239], v37 offset:4608
  v_mfma_f32_32x32x16_bf16 v[160:175], a[244:247], a[40:43], v[160:175]
  v_mfma_f32_32x32x16_bf16 v[176:191], a[244:247], a[44:47], v[176:191]
  s_waitcnt lgkmcnt(4)
  v_mfma_f32_32x32x16_bf16 v[128:143], a[224:227], a[48:51], v[128:143]
  s_waitcnt vmcnt(10)
  v_cmp_eq_u32_e64 vcc, 0, v68
  s_nop 0
  s_cbranch_vccz L_ok_6
  s_mov_b32 s94, 0
L_spin_7:
  s_sleep 8
  buffer_load_dword v68, v73, s[32:35], 0 offen sc1
  s_add_u32 s94, s94, 1
  s_waitcnt vmcnt(0)
  v_cmp_eq_u32_e64 vcc, 0, v68
  s_cmp_gt_u32 s94, 3145728
  s_cbranch_scc1 L_ok_6
  s_cbranch_vccnz L_spin_7
L_ok_6:
  s_waitcnt vmcnt(6)
  s_barrier
  ds_read_b64_tr_b16 a[240:241], v30 offset:32768
  ds_read_b64_tr_b16 a[242:243], v30 offset:33280
  v_mfma_f32_32x32x16_bf16 v[144:159], a[224:227], a[52:55], v[144:159]
  ds_read_b64_tr_b16 a[244:245], v32 offset:32768
  ds_read_b64_tr_b16 a[246:247], v32 offset:33280
  buffer_store_byte v79, v48, s[12:15], 0 offen sc1
  v_mfma_f32_32x32x16_bf16 v[160:175], a[228:231], a[48:51], v[160:175]
  s_add_u32 m0, s56, 81920
  s_mul_i32 s93, s48, 229376
  s_add_u32 s93, s93, s0
  buffer_load_dwordx4 v14, s[24:27], s93 offen offset:0 lds
  v_mfma_f32_32x32x16_bf16 v[176:191], a[228:231], a[52:55], v[176:191]
  buffer_load_dwordx4 v15, s[24:27], s93 offen offset:1024 lds
  v_mfma_f32_16x16x32_bf16 v[84:87], v[80:83], a[224:227], v[84:87]
  v_mfma_f32_16x16x32_bf16 v[88:91], v[80:83], a[228:231], v[88:91]
  s_waitcnt lgkmcnt(4)
  v_mfma_f32_32x32x16_bf16 v[128:143], a[232:235], a[56:59], v[128:143]
  ds_read_b64_tr_b16 a[224:225], v31 offset:32768
  ds_read_b64_tr_b16 a[226:227], v31 offset:33280
  v_mfma_f32_32x32x16_bf16 v[144:159], a[232:235], a[60:63], v[144:159]
  ds_read_b64_tr_b16 a[228:229], v33 offset:32768
  ds_read_b64_tr_b16 a[230:231], v33 offset:33280
  v_mfma_f32_32x32x16_bf16 v[160:175], a[236:239], a[56:59], v[160:175]
  buffer_load_dwordx4 v16, s[24:27], s93 offen offset:2048 lds
  v_mfma_f32_32x32x16_bf16 v[176:191], a[236:239], a[60:63], v[176:191]
  s_lshl_b32 s57, s3, 11
  v_lshlrev_b32 v67, 3, v1
  v_add_u32_e64 v67, s57, v67
  v_add_u32 v67, 155648, v67
  v_mov_b32 v2, v84
  v_mov_b32 v3, v88
  ds_write_b64 v67, v[2:3]
  v_xor_b32 v67, 0x800, v67
  s_cmp_eq_u32 s61, 0
  s_cbranch_scc1 L_passC_8
  s_waitcnt lgkmcnt(5)
  v_mfma_f32_32x32x16_bf16 v[192:207], a[240:243], a[64:67], 0
  ds_read_b64_tr_b16 a[232:233], v30 offset:36864
  ds_read_b64_tr_b16 a[234:235], v30 offset:37376
  v_mfma_f32_32x32x16_bf16 v[208:223], a[240:243], a[68:71], 0
  ds_read_b64_tr_b16 a[236:237], v32 offset:36864
  ds_read_b64_tr_b16 a[238:239], v32 offset:37376
  v_mfma_f32_32x32x16_bf16 v[224:239], a[244:247], a[64:67], 0
  buffer_load_dwordx4 v17, s[24:27], s93 offen offset:3072 lds
  v_mfma_f32_32x32x16_bf16 v[240:255], a[244:247], a[68:71], 0
  v_mfma_f32_16x16x32_bf16 v[84:87], v[80:83], a[240:243], 0
  v_mfma_f32_16x16x32_bf16 v[88:91], v[80:83], a[244:247], 0
  s_waitcnt lgkmcnt(5)
  v_mfma_f32_32x32x16_bf16 v[192:207], a[224:227], a[72:75], v[192:207]
  ds_read_b64_tr_b16 a[240:241], v31 offset:36864
  ds_read_b64_tr_b16 a[242:243], v31 offset:37376
  v_mfma_f32_32x32x16_bf16 v[208:223], a[224:227], a[76:79], v[208:223]
  ds_read_b64_tr_b16 a[244:245], v33 offset:36864
  ds_read_b64_tr_b16 a[246:247], v33 offset:37376
  v_mfma_f32_32x32x16_bf16 v[224:239], a[228:231], a[72:75], v[224:239]
  v_mfma_f32_32x32x16_bf16 v[240:255], a[228:231], a[76:79], v[240:255]
  s_waitcnt lgkmcnt(4)
  v_mfma_f32_32x32x16_bf16 v[192:207], a[232:235], a[80:83], v[192:207]
  s_barrier
  ds_read_b64_tr_b16 a[224:225], v30 offset:0
  ds_read_b64_tr_b16 a[226:227], v30 offset:512
  ds_read_b64 v[4:5], v67
  v_cmp_eq_u32 s[74:75], 0, v51
  v_mfma_f32_32x32x16_bf16 v[208:223], a[232:235], a[84:87], v[208:223]
  ds_read_b64_tr_b16 a[228:229], v32 offset:0
  ds_read_b64_tr_b16 a[230:231], v32 offset:512
  s_nop 0
  s_nop 0
  s_nop 0
  s_nop 0
  v_mfma_f32_32x32x16_bf16 v[224:239], a[236:239], a[80:83], v[224:239]
  s_add_u32 m0, s56, 65536
  s_mul_i32 s93, s49, 229376
  s_add_u32 s93, s93, s0
  buffer_load_dwordx4 v14, s[24:27], s93 offen offset:0 lds
  v_mfma_f32_32x32x16_bf16 v[240:255], a[236:239], a[84:87], v[240:255]
  buffer_load_dwordx4 v15, s[24:27], s93 offen offset:1024 lds
  s_waitcnt lgkmcnt(2)
  v_cndmask_b32 v65, v4, v2, s[74:75]
  v_cndmask_b32 v66, v5, v3, s[74:75]
  v_mfma_f32_16x16x32_bf16 v[84:87], v[80:83], a[232:235], v[84:87]
  v_and_b32 v63, 0xffff0000, v65
  v_sub_f32_e64 v63, v65, v63
  v_mfma_f32_16x16x32_bf16 v[88:91], v[80:83], a[236:239], v[88:91]
  v_perm_b32 v2, v63, v65, s72
  v_mfma_f32_32x32x16_bf16 v[192:207], a[240:243], a[88:91], v[192:207]
  ds_read_b64_tr_b16 a[232:233], v31 offset:0
  ds_read_b64_tr_b16 a[234:235], v31 offset:512
  v_and_b32 v3, 0xffff0000, v63
  v_sub_f32 v63, v63, v3
  v_lshrrev_b32 v3, 16, v63
  v_mov_b32_e64 v4, 0
  v_mfma_f32_32x32x16_bf16 v[208:223], a[240:243], a[92:95], v[208:223]
  ds_read_b64_tr_b16 a[236:237], v33 offset:0
  ds_read_b64_tr_b16 a[238:239], v33 offset:512
  v_mov_b32_e64 v5, 0
  v_and_b32 v63, 0xffff0000, v66
  v_sub_f32_e64 v63, v66, v63
  v_perm_b32 v6, v63, v66, s72
  v_mfma_f32_32x32x16_bf16 v[224:239], a[244:247], a[88:91], v[224:239]
  buffer_load_dwordx4 v16, s[24:27], s93 offen offset:2048 lds
  v_and_b32 v7, 0xffff0000, v63
  v_sub_f32 v63, v63, v7
  v_lshrrev_b32 v7, 16, v63
  v_mfma_f32_32x32x16_bf16 v[240:255], a[244:247], a[92:95], v[240:255]
  v_mov_b32 v8, 0
  v_mov_b32_e64 v9, 0
  s_waitcnt lgkmcnt(4)
  v_mfma_f32_32x32x16_bf16 v[192:207], a[224:227], a[96:99], v[192:207]
  ds_read_b64_tr_b16 a[240:241], v30 offset:4096
  ds_read_b64_tr_b16 a[242:243], v30 offset:4608
  v_mfma_f32_32x32x16_bf16 v[128:143], v[2:5], v[18:21], v[128:143]
  v_mfma_f32_32x32x16_bf16 v[144:159], v[2:5], v[22:25], v[144:159]
  v_mfma_f32_32x32x16_bf16 v[160:175], v[6:9], v[18:21], v[160:175]
  v_mfma_f32_32x32x16_bf16 v[176:191], v[6:9], v[22:25], v[176:191]
  v_mfma_f32_32x32x16_bf16 v[208:223], a[224:227], a[100:103], v[208:223]
  ds_read_b64_tr_b16 a[244:245], v32 offset:4096
  ds_read_b64_tr_b16 a[246:247], v32 offset:4608
  s_nop 3
  s_nop 3
  s_lshl1_add_u32 s57, s88, s7
  s_mul_i32 s57, s57, 133120
  v_mfma_f32_32x32x16_bf16 v[224:239], a[228:231], a[96:99], v[224:239]
  buffer_load_dwordx4 v17, s[24:27], s93 offen offset:3072 lds
  s_add_u32 s57, s57, 65536
  s_add_u32 s58, s57, 266240
  v_mul_f32 v128, v128, v60
  v_mfma_f32_32x32x16_bf16 v[240:255], a[228:231], a[100:103], v[240:255]
  v_mul_f32 v129, v129, v60
  v_mul_f32 v130, v130, v60
  v_mul_f32 v131, v131, v60
  v_mul_f32 v132, v132, v60
  v_mul_f32 v133, v133, v60
  v_mul_f32 v134, v134, v60
  v_mfma_f32_16x16x32_bf16 v[84:87], v[80:83], a[224:227], v[84:87]
  v_mul_f32 v135, v135, v60
  v_mul_f32 v136, v136, v60
  v_mfma_f32_16x16x32_bf16 v[88:91], v[80:83], a[228:231], v[88:91]
  v_mul_f32 v137, v137, v60
  s_waitcnt lgkmcnt(4)
  v_mfma_f32_32x32x16_bf16 v[192:207], a[232:235], a[104:107], v[192:207]
  ds_read_b64_tr_b16 a[224:225], v31 offset:4096
  ds_read_b64_tr_b16 a[226:227], v31 offset:4608
  v_mul_f32 v138, v138, v60
  v_mul_f32 v139, v139, v60
  v_mul_f32 v140, v140, v60
  v_mul_f32 v141, v141, v60
  v_mfma_f32_32x32x16_bf16 v[208:223], a[232:235], a[108:111], v[208:223]
  ds_read_b64_tr_b16 a[228:229], v33 offset:4096
  ds_read_b64_tr_b16 a[230:231], v33 offset:4608
  v_mul_f32 v142, v142, v60
  v_mul_f32 v143, v143, v60
  v_cvt_pk_bf16_f32 v128, v128, v129
  v_cvt_pk_bf16_f32 v129, v130, v131
  v_mfma_f32_32x32x16_bf16 v[224:239], a[236:239], a[104:107], v[224:239]
  v_cvt_pk_bf16_f32 v130, v132, v133
  v_cvt_pk_bf16_f32 v131, v134, v135
  v_cvt_pk_bf16_f32 v132, v136, v137
  v_cvt_pk_bf16_f32 v133, v138, v139
  v_cvt_pk_bf16_f32 v134, v140, v141
  v_cvt_pk_bf16_f32 v135, v142, v143
  v_mfma_f32_32x32x16_bf16 v[240:255], a[236:239], a[108:111], v[240:255]
  buffer_store_dwordx2 v[128:129], v49, s[28:31], s57 offen offset:0 sc1
  s_waitcnt lgkmcnt(4)
  v_mfma_f32_32x32x16_bf16 v[192:207], a[240:243], a[112:115], v[192:207]
  s_barrier
  ds_read_b64_tr_b16 a[232:233], v30 offset:16384
  ds_read_b64_tr_b16 a[234:235], v30 offset:16896
  v_mfma_f32_32x32x16_bf16 v[208:223], a[240:243], a[116:119], v[208:223]
  ds_read_b64_tr_b16 a[236:237], v32 offset:16384
  ds_read_b64_tr_b16 a[238:239], v32 offset:16896
  s_add_u32 s78, s57, 33280
  buffer_store_dwordx2 v[130:131], v49, s[28:31], s78 offen offset:0 sc1
  v_mfma_f32_32x32x16_bf16 v[224:239], a[244:247], a[112:115], v[224:239]
  s_add_u32 m0, s56, 32768
  s_add_u32 s93, s100, 0
  buffer_load_dwordx4 v74, s[36:39], s93 offen offset:0 lds
  v_mfma_f32_32x32x16_bf16 v[240:255], a[244:247], a[116:119], v[240:255]
  buffer_load_dwordx4 v75, s[36:39], s93 offen offset:1024 lds
  buffer_store_dwordx2 v[132:133], v49, s[28:31], s58 offen offset:0 sc1
  v_mfma_f32_16x16x32_bf16 v[84:87], v[80:83], a[240:243], v[84:87]
  v_mfma_f32_16x16x32_bf16 v[88:91], v[80:83], a[244:247], v[88:91]
  s_waitcnt lgkmcnt(4)
  v_mfma_f32_32x32x16_bf16 v[192:207], a[224:227], a[120:123], v[192:207]
  ds_read_b64_tr_b16 a[240:241], v31 offset:16384
  ds_read_b64_tr_b16 a[242:243], v31 offset:16896
  s_add_u32 s78, s58, 33280
  buffer_store_dwordx2 v[134:135], v49, s[28:31], s78 offen offset:0 sc1
  v_mfma_f32_32x32x16_bf16 v[208:223], a[224:227], a[124:127], v[208:223]
  ds_read_b64_tr_b16 a[244:245], v33 offset:16384
  ds_read_b64_tr_b16 a[246:247], v33 offset:16896
  v_mul_f32 v144, v144, v61
  v_mul_f32 v145, v145, v61
  v_mul_f32 v146, v146, v61
  v_mul_f32 v147, v147, v61
  v_mfma_f32_32x32x16_bf16 v[224:239], a[228:231], a[120:123], v[224:239]
  buffer_load_dwordx4 v76, s[36:39], s93 offen offset:2048 lds
  v_mul_f32 v148, v148, v61
  v_mul_f32 v149, v149, v61
  v_mul_f32_e64 v150, v150, v61
  v_mfma_f32_32x32x16_bf16 v[240:255], a[228:231], a[124:127], v[240:255]
  v_mul_f32 v151, v151, v61
  v_mul_f32 v152, v152, v61
  v_mul_f32 v153, v153, v61
  v_mul_f32 v154, v154, v61
  v_mul_f32 v155, v155, v61
  s_waitcnt lgkmcnt(4)
  v_mfma_f32_32x32x16_bf16 v[192:207], a[232:235], a[128:131], v[192:207]
  ds_read_b64_tr_b16 a[224:225], v30 offset:20480
  ds_read_b64_tr_b16 a[226:227], v30 offset:20992
  v_mul_f32 v156, v156, v61
  v_mul_f32 v157, v157, v61
  v_mul_f32 v158, v158, v61
  v_mul_f32 v159, v159, v61
  v_mfma_f32_32x32x16_bf16 v[208:223], a[232:235], a[132:135], v[208:223]
  ds_read_b64_tr_b16 a[228:229], v32 offset:20480
  ds_read_b64_tr_b16 a[230:231], v32 offset:20992
  v_cvt_pk_bf16_f32 v144, v144, v145
  v_cvt_pk_bf16_f32 v145, v146, v147
  v_cvt_pk_bf16_f32 v146, v148, v149
  v_cvt_pk_bf16_f32 v147, v150, v151
  v_mfma_f32_32x32x16_bf16 v[224:239], a[236:239], a[128:131], v[224:239]
  buffer_load_dwordx4 v77, s[36:39], s93 offen offset:3072 lds
  v_cvt_pk_bf16_f32 v148, v152, v153
  v_cvt_pk_bf16_f32 v149, v154, v155
  v_cvt_pk_bf16_f32 v150, v156, v157
  v_mfma_f32_32x32x16_bf16 v[240:255], a[236:239], a[132:135], v[240:255]
  v_cvt_pk_bf16_f32 v151, v158, v159
  buffer_store_dwordx2 v[144:145], v49, s[28:31], s57 offen offset:256 sc1
  v_mfma_f32_16x16x32_bf16 v[84:87], v[80:83], a[232:235], v[84:87]
  v_mfma_f32_16x16x32_bf16 v[88:91], v[80:83], a[236:239], v[88:91]
  s_waitcnt lgkmcnt(4)
  v_mfma_f32_32x32x16_bf16 v[192:207], a[240:243], a[136:139], v[192:207]
  ds_read_b64_tr_b16 a[232:233], v31 offset:20480
  ds_read_b64_tr_b16 a[234:235], v31 offset:20992
  s_add_u32 s78, s57, 33280
  buffer_store_dwordx2 v[146:147], v49, s[28:31], s78 offen offset:256 sc1
  v_mfma_f32_32x32x16_bf16 v[208:223], a[240:243], a[140:143], v[208:223]
  ds_read_b64_tr_b16 a[236:237], v33 offset:20480
  ds_read_b64_tr_b16 a[238:239], v33 offset:20992
  buffer_store_dwordx2 v[148:149], v49, s[28:31], s58 offen offset:256 sc1
  v_mfma_f32_32x32x16_bf16 v[224:239], a[244:247], a[136:139], v[224:239]
  s_add_u32 s78, s58, 33280
  buffer_store_dwordx2 v[150:151], v49, s[28:31], s78 offen offset:256 sc1
  s_lshl1_add_u32 s57, s88, s7
  s_mul_i32 s57, s57, 133120
  v_mfma_f32_32x32x16_bf16 v[240:255], a[244:247], a[140:143], v[240:255]
  s_add_u32 s57, s57, 132096
  s_add_u32 s58, s57, 266240
  v_mul_f32 v160, v160, v60
  v_mul_f32 v161, v161, v60
  v_mul_f32 v162, v162, v60
  s_waitcnt lgkmcnt(4)
  v_mfma_f32_32x32x16_bf16 v[192:207], a[224:227], a[144:147], v[192:207]
  s_barrier
  ds_read_b64_tr_b16 a[240:241], v30 offset:49152
  ds_read_b64_tr_b16 a[242:243], v30 offset:49664
  v_mul_f32 v163, v163, v60
  v_mul_f32_e64 v164, v164, v60
  v_mfma_f32_32x32x16_bf16 v[208:223], a[224:227], a[148:151], v[208:223]
  ds_read_b64_tr_b16 a[244:245], v32 offset:49152
  ds_read_b64_tr_b16 a[246:247], v32 offset:49664
  v_mul_f32 v165, v165, v60
  v_mul_f32 v166, v166, v60
  v_mul_f32 v167, v167, v60
  v_mul_f32 v168, v168, v60
  v_mfma_f32_32x32x16_bf16 v[224:239], a[228:231], a[144:147], v[224:239]
  s_add_u32 m0, s56, 0
  s_add_u32 s93, s100, 28672
  buffer_load_dwordx4 v74, s[36:39], s93 offen offset:0 lds
  v_mul_f32 v169, v169, v60
  v_mfma_f32_32x32x16_bf16 v[240:255], a[228:231], a[148:151], v[240:255]
  buffer_load_dwordx4 v75, s[36:39], s93 offen offset:1024 lds
  v_mul_f32 v170, v170, v60
  v_mul_f32 v171, v171, v60
  v_mul_f32_e64 v172, v172, v60
  v_mfma_f32_16x16x32_bf16 v[84:87], v[80:83], a[224:227], v[84:87]
  v_mul_f32 v173, v173, v60
  v_mul_f32 v174, v174, v60
  v_mfma_f32_16x16x32_bf16 v[88:91], v[80:83], a[228:231], v[88:91]
  v_mul_f32 v175, v175, v60
  s_waitcnt lgkmcnt(4)
  v_mfma_f32_32x32x16_bf16 v[192:207], a[232:235], a[152:155], v[192:207]
  ds_read_b64_tr_b16 a[224:225], v31 offset:49152
  ds_read_b64_tr_b16 a[226:227], v31 offset:49664
  v_cvt_pk_bf16_f32 v160, v160, v161
  v_cvt_pk_bf16_f32 v161, v162, v163
  v_cvt_pk_bf16_f32 v162, v164, v165
  v_cvt_pk_bf16_f32 v163, v166, v167
  v_mfma_f32_32x32x16_bf16 v[208:223], a[232:235], a[156:159], v[208:223]
  ds_read_b64_tr_b16 a[228:229], v33 offset:49152
  ds_read_b64_tr_b16 a[230:231], v33 offset:49664
  v_cvt_pk_bf16_f32 v164, v168, v169
  v_cvt_pk_bf16_f32 v165, v170, v171
  v_cvt_pk_bf16_f32 v166, v172, v173
  v_cvt_pk_bf16_f32 v167, v174, v175
  v_mfma_f32_32x32x16_bf16 v[224:239], a[236:239], a[152:155], v[224:239]
  buffer_load_dwordx4 v76, s[36:39], s93 offen offset:2048 lds
  buffer_store_dwordx2 v[160:161], v49, s[28:31], s57 offen offset:0 sc1
  v_mfma_f32_32x32x16_bf16 v[240:255], a[236:239], a[156:159], v[240:255]
  s_add_u32 s78, s57, 33280
  buffer_store_dwordx2 v[162:163], v49, s[28:31], s78 offen offset:0 sc1
  s_waitcnt lgkmcnt(4)
  v_mfma_f32_32x32x16_bf16 v[192:207], a[240:243], a[160:163], v[192:207]
  ds_read_b64_tr_b16 a[232:233], v30 offset:53248
  ds_read_b64_tr_b16 a[234:235], v30 offset:53760
  s_cmp_lg_u32 s3, 0
  s_cbranch_scc1 L_pw_12
  s_load_dwordx2 s[20:21], s[64:65], 0 glc
L_pw_12:
  s_mul_i32 s74, s5, 7
  s_add_u32 s74, s74, s3
  s_mul_i32 s74, s74, 16640
  v_mfma_f32_32x32x16_bf16 v[208:223], a[240:243], a[164:167], v[208:223]
  ds_read_b64_tr_b16 a[236:237], v32 offset:53248
  ds_read_b64_tr_b16 a[238:239], v32 offset:53760
  s_lshl_b32 s75, s4, 10
  s_add_u32 s74, s74, s75
  s_mul_i32 s75, s3, 3072
  s_mul_i32 s76, s3, 3104
  v_mfma_f32_32x32x16_bf16 v[224:239], a[244:247], a[160:163], v[224:239]
  buffer_load_dwordx4 v77, s[36:39], s93 offen offset:3072 lds
  s_mul_i32 s59, s5, 116480
  s_lshl2_add_u32 s60, s4, s3
  s_lshl_b32 s60, s60, 8
  v_mfma_f32_32x32x16_bf16 v[240:255], a[244:247], a[164:167], v[240:255]
  s_add_u32 s59, s59, s60
  v_mul_u32_u24 v65, 33280, v51
  v_lshl_add_u32 v65, v53, 3, v65
  buffer_store_dwordx2 v[164:165], v49, s[28:31], s58 offen offset:0 sc1
  v_mfma_f32_16x16x32_bf16 v[84:87], v[80:83], a[240:243], v[84:87]
  v_mfma_f32_16x16x32_bf16 v[88:91], v[80:83], a[244:247], v[88:91]
  s_waitcnt lgkmcnt(4)
  v_mfma_f32_32x32x16_bf16 v[192:207], a[224:227], a[168:171], v[192:207]
  ds_read_b64_tr_b16 a[240:241], v31 offset:53248
  ds_read_b64_tr_b16 a[242:243], v31 offset:53760
  s_add_u32 s78, s58, 33280
  buffer_store_dwordx2 v[166:167], v49, s[28:31], s78 offen offset:0 sc1
  v_mfma_f32_32x32x16_bf16 v[208:223], a[224:227], a[172:175], v[208:223]
  ds_read_b64_tr_b16 a[244:245], v33 offset:53248
  ds_read_b64_tr_b16 a[246:247], v33 offset:53760
  v_mul_f32 v176, v176, v61
  v_mul_f32 v177, v177, v61
  v_mul_f32 v178, v178, v61
  v_mul_f32_e64 v179, v179, v61
  v_mfma_f32_32x32x16_bf16 v[224:239], a[228:231], a[168:171], v[224:239]
  v_mul_f32 v180, v180, v61
  v_mul_f32 v181, v181, v61
  v_mul_f32 v182, v182, v61
  v_mul_f32 v183, v183, v61
  v_mul_f32 v184, v184, v61
  v_mul_f32 v185, v185, v61
  v_mfma_f32_32x32x16_bf16 v[240:255], a[228:231], a[172:175], v[240:255]
  v_mul_f32 v186, v186, v61
  v_mul_f32 v187, v187, v61
  v_mul_f32 v188, v188, v61
  v_mul_f32 v189, v189, v61
  v_mul_f32 v190, v190, v61
  s_waitcnt lgkmcnt(4)
  v_mfma_f32_32x32x16_bf16 v[192:207], a[232:235], a[176:179], v[192:207]
  s_waitcnt vmcnt(29)
  s_barrier
  ds_read_b64_tr_b16 a[224:225], v34 offset:32768
  ds_read_b64_tr_b16 a[226:227], v34 offset:33280
  v_mul_f32_e64 v191, v191, v61
  v_cvt_pk_bf16_f32 v176, v176, v177
  v_mfma_f32_32x32x16_bf16 v[208:223], a[232:235], a[180:183], v[208:223]
  ds_read_b64_tr_b16 a[228:229], v36 offset:32768
  ds_read_b64_tr_b16 a[230:231], v36 offset:33280
  v_cvt_pk_bf16_f32 v177, v178, v179
  v_cvt_pk_bf16_f32 v178, v180, v181
  v_cvt_pk_bf16_f32 v179, v182, v183
  v_cvt_pk_bf16_f32 v180, v184, v185
  v_mfma_f32_32x32x16_bf16 v[224:239], a[236:239], a[176:179], v[224:239]
  s_add_u32 m0, s56, 16384
  s_add_u32 s93, s100, 114688
  buffer_load_dwordx4 v74, s[36:39], s93 offen offset:0 lds
  v_cvt_pk_bf16_f32 v181, v186, v187
  v_mfma_f32_32x32x16_bf16 v[240:255], a[236:239], a[180:183], v[240:255]
  buffer_load_dwordx4 v75, s[36:39], s93 offen offset:1024 lds
  v_cvt_pk_bf16_f32 v182, v188, v189
  v_cvt_pk_bf16_f32 v183, v190, v191
  v_mfma_f32_16x16x32_bf16 v[84:87], v[80:83], a[232:235], v[84:87]
  v_mfma_f32_16x16x32_bf16 v[88:91], v[80:83], a[236:239], v[88:91]
  s_waitcnt lgkmcnt(4)
  v_mfma_f32_32x32x16_bf16 v[192:207], a[240:243], a[184:187], v[192:207]
  ds_read_b64_tr_b16 a[232:233], v35 offset:32768
  ds_read_b64_tr_b16 a[234:235], v35 offset:33280
  buffer_store_dwordx2 v[176:177], v49, s[28:31], s57 offen offset:256 sc1
  v_mfma_f32_32x32x16_bf16 v[208:223], a[240:243], a[188:191], v[208:223]
  ds_read_b64_tr_b16 a[236:237], v37 offset:32768
  ds_read_b64_tr_b16 a[238:239], v37 offset:33280
  s_add_u32 s78, s57, 33280
  buffer_store_dwordx2 v[178:179], v49, s[28:31], s78 offen offset:256 sc1
  v_mfma_f32_32x32x16_bf16 v[224:239], a[244:247], a[184:187], v[224:239]
  buffer_load_dwordx4 v76, s[36:39], s93 offen offset:2048 lds
  buffer_store_dwordx2 v[180:181], v49, s[28:31], s58 offen offset:256 sc1
  v_mfma_f32_32x32x16_bf16 v[240:255], a[244:247], a[188:191], v[240:255]
  s_add_u32 s78, s58, 33280
  buffer_store_dwordx2 v[182:183], v49, s[28:31], s78 offen offset:256 sc1
  s_waitcnt lgkmcnt(4)
  v_mfma_f32_32x32x16_bf16 v[192:207], a[224:227], a[192:195], v[192:207]
  ds_read_b64_tr_b16 a[240:241], v34 offset:36864
  ds_read_b64_tr_b16 a[242:243], v34 offset:37376
  v_mfma_f32_32x32x16_bf16 v[208:223], a[224:227], a[196:199], v[208:223]
  ds_read_b64_tr_b16 a[244:245], v36 offset:36864
  ds_read_b64_tr_b16 a[246:247], v36 offset:37376
  v_mfma_f32_32x32x16_bf16 v[224:239], a[228:231], a[192:195], v[224:239]
  buffer_load_dwordx4 v77, s[36:39], s93 offen offset:3072 lds
  v_mfma_f32_32x32x16_bf16 v[240:255], a[228:231], a[196:199], v[240:255]
  v_mfma_f32_16x16x32_bf16 v[84:87], v[80:83], a[224:227], v[84:87]
  v_mfma_f32_16x16x32_bf16 v[88:91], v[80:83], a[228:231], v[88:91]
  s_waitcnt lgkmcnt(4)
  v_mfma_f32_32x32x16_bf16 v[192:207], a[232:235], a[200:203], v[192:207]
  ds_read_b64_tr_b16 a[224:225], v35 offset:36864
  ds_read_b64_tr_b16 a[226:227], v35 offset:37376
  v_mfma_f32_32x32x16_bf16 v[208:223], a[232:235], a[204:207], v[208:223]
  ds_read_b64_tr_b16 a[228:229], v37 offset:36864
  ds_read_b64_tr_b16 a[230:231], v37 offset:37376
  v_mfma_f32_32x32x16_bf16 v[224:239], a[236:239], a[200:203], v[224:239]
  v_mfma_f32_32x32x16_bf16 v[240:255], a[236:239], a[204:207], v[240:255]
  s_waitcnt lgkmcnt(4)
  v_mfma_f32_32x32x16_bf16 v[192:207], a[240:243], a[208:211], v[192:207]
  s_waitcnt vmcnt(1)
  s_barrier
  ds_read_b64_tr_b16 a[232:233], v34 offset:16384
  ds_read_b64_tr_b16 a[234:235], v34 offset:16896
  v_mfma_f32_32x32x16_bf16 v[208:223], a[240:243], a[212:215], v[208:223]
  ds_read_b64_tr_b16 a[236:237], v36 offset:16384
  ds_read_b64_tr_b16 a[238:239], v36 offset:16896
  buffer_store_byte v79, v71, s[12:15], 0 offen sc1
  v_mfma_f32_32x32x16_bf16 v[224:239], a[244:247], a[208:211], v[224:239]
  s_add_u32 m0, s56, 49152
  s_add_u32 s93, s100, 143360
  buffer_load_dwordx4 v74, s[36:39], s93 offen offset:0 lds
  v_mfma_f32_32x32x16_bf16 v[240:255], a[244:247], a[212:215], v[240:255]
  buffer_load_dwordx4 v75, s[36:39], s93 offen offset:1024 lds
  v_mfma_f32_16x16x32_bf16 v[84:87], v[80:83], a[240:243], v[84:87]
  v_mfma_f32_16x16x32_bf16 v[88:91], v[80:83], a[244:247], v[88:91]
  s_waitcnt lgkmcnt(4)
  v_mfma_f32_32x32x16_bf16 v[192:207], a[224:227], a[216:219], v[192:207]
  ds_read_b64_tr_b16 a[240:241], v35 offset:16384
  ds_read_b64_tr_b16 a[242:243], v35 offset:16896
  v_mfma_f32_32x32x16_bf16 v[208:223], a[224:227], a[220:223], v[208:223]
  ds_read_b64_tr_b16 a[244:245], v37 offset:16384
  ds_read_b64_tr_b16 a[246:247], v37 offset:16896
  v_mfma_f32_32x32x16_bf16 v[224:239], a[228:231], a[216:219], v[224:239]
  buffer_load_dwordx4 v76, s[36:39], s93 offen offset:2048 lds
  v_mfma_f32_32x32x16_bf16 v[240:255], a[228:231], a[220:223], v[240:255]
  s_waitcnt lgkmcnt(4)
  v_mfma_f32_32x32x16_bf16 v[192:207], a[232:235], a[0:3], v[192:207]
  ds_read_b64_tr_b16 a[224:225], v34 offset:20480
  ds_read_b64_tr_b16 a[226:227], v34 offset:20992
  v_mfma_f32_32x32x16_bf16 v[208:223], a[232:235], a[4:7], v[208:223]
  ds_read_b64_tr_b16 a[228:229], v36 offset:20480
  ds_read_b64_tr_b16 a[230:231], v36 offset:20992
  v_mfma_f32_32x32x16_bf16 v[224:239], a[236:239], a[0:3], v[224:239]
  buffer_load_dwordx4 v77, s[36:39], s93 offen offset:3072 lds
  v_mfma_f32_32x32x16_bf16 v[240:255], a[236:239], a[4:7], v[240:255]
  v_mfma_f32_16x16x32_bf16 v[84:87], v[80:83], a[232:235], v[84:87]
  v_mfma_f32_16x16x32_bf16 v[88:91], v[80:83], a[236:239], v[88:91]
  s_waitcnt lgkmcnt(4)
  v_mfma_f32_32x32x16_bf16 v[192:207], a[240:243], a[8:11], v[192:207]
  ds_read_b64_tr_b16 a[232:233], v35 offset:20480
  ds_read_b64_tr_b16 a[234:235], v35 offset:20992
  v_mfma_f32_32x32x16_bf16 v[208:223], a[240:243], a[12:15], v[208:223]
  ds_read_b64_tr_b16 a[236:237], v37 offset:20480
  ds_read_b64_tr_b16 a[238:239], v37 offset:20992
  v_mfma_f32_32x32x16_bf16 v[224:239], a[244:247], a[8:11], v[224:239]
  v_mfma_f32_32x32x16_bf16 v[240:255], a[244:247], a[12:15], v[240:255]
  s_waitcnt lgkmcnt(4)
  v_mfma_f32_32x32x16_bf16 v[192:207], a[224:227], a[16:19], v[192:207]
  s_cmp_lg_u32 s3, 0
  s_cbranch_scc1 L_pw_13
  s_waitcnt lgkmcnt(0)
  s_andn2_b32 s20, s68, s20
  s_andn2_b32 s21, s73, s21
  s_or_b32 s20, s20, s21
  s_cmp_eq_u32 s20, 0
  s_cbranch_scc1 L_ok_10
  s_mov_b32 s94, 0
L_spin_11:
  s_sleep 4
  s_load_dwordx2 s[20:21], s[64:65], 0 glc
  s_add_u32 s94, s94, 1
  s_cmp_gt_u32 s94, 3145728
  s_cbranch_scc1 L_ok_10
  s_waitcnt lgkmcnt(0)
  s_andn2_b32 s20, s68, s20
  s_andn2_b32 s21, s73, s21
  s_or_b32 s20, s20, s21
  s_cmp_eq_u32 s20, 0
  s_cbranch_scc0 L_spin_11
L_ok_10:
L_pw_13:
  s_barrier
  ds_read_b64_tr_b16 a[240:241], v34 offset:0
  ds_read_b64_tr_b16 a[242:243], v34 offset:512
  v_min_u32 v62, 191, v0
  s_lshl_b32 s79, s4, 6
  v_mfma_f32_32x32x16_bf16 v[208:223], a[224:227], a[20:23], v[208:223]
  ds_read_b64_tr_b16 a[244:245], v36 offset:0
  ds_read_b64_tr_b16 a[246:247], v36 offset:512
  v_add_u32_e64 v66, s79, v62
  v_mov_b32 v67, 0xf14a
  v_cmp_gt_u32 vcc, 128, v66
  v_mov_b32_e64 v129, 0
  v_mfma_f32_32x32x16_bf16 v[224:239], a[228:231], a[16:19], v[224:239]
  s_add_u32 m0, s75, 114688
  s_add_u32 s77, s74, 1927168
  buffer_load_dwordx4 v10, s[12:15], s77 offen offset:0 sc1 lds
  v_mov_b32_e64 v131, 0
  v_mfma_f32_32x32x16_bf16 v[240:255], a[228:231], a[20:23], v[240:255]
  buffer_load_dwordx4 v11, s[12:15], s77 offen offset:1024 sc1 lds
  v_cndmask_b32 v128, 0, v67, vcc
  v_cndmask_b32 v130, 0, v67, vcc
  v_lshlrev_b32_e64 v62, 4, v62
  v_mfma_f32_16x16x32_bf16 v[84:87], v[80:83], a[224:227], v[84:87]
  v_add_u32 v62, 136192, v62
  ds_write_b128 v62, v[128:131]
  v_mfma_f32_16x16x32_bf16 v[88:91], v[80:83], a[228:231], v[88:91]
  v_min_u32 v66, 147, v0
  s_waitcnt lgkmcnt(5)
  v_mfma_f32_32x32x16_bf16 v[192:207], a[232:235], a[24:27], v[192:207]
  ds_read_b64_tr_b16 a[224:225], v35 offset:0
  ds_read_b64_tr_b16 a[226:227], v35 offset:512
  v_lshlrev_b32 v66, 4, v66
  v_add_u32 v66, 160992, v66
  v_mov_b32 v132, 0x3f803f80
  v_mov_b32 v133, 0x3f803f80
  v_mfma_f32_32x32x16_bf16 v[208:223], a[232:235], a[28:31], v[208:223]
  ds_read_b64_tr_b16 a[228:229], v37 offset:0
  ds_read_b64_tr_b16 a[230:231], v37 offset:512
  v_mov_b32 v134, 0x3f803f80
  v_mov_b32 v135, 0x3f803f80
  ds_write_b128 v66, v[132:135]
  s_lshl_b32 s79, s3, 11
  v_mfma_f32_32x32x16_bf16 v[224:239], a[236:239], a[24:27], v[224:239]
  buffer_load_dwordx4 v12, s[12:15], s77 offen offset:2048 sc1 lds
  v_lshlrev_b32 v63, 3, v1
  v_add_u32_e64 v63, s79, v63
  v_add_u32 v63, 98304, v63
  v_mfma_f32_32x32x16_bf16 v[240:255], a[236:239], a[28:31], v[240:255]
  s_cmp_eq_u32 s3, 3
  s_cbranch_scc1 L_w3_14
  s_add_u32 m0, s75, 126976
  s_add_u32 s77, s74, 1993728
  buffer_load_dwordx4 v10, s[12:15], s77 offen offset:0 sc1 lds
  buffer_load_dwordx4 v11, s[12:15], s77 offen offset:1024 sc1 lds
  buffer_load_dwordx4 v12, s[12:15], s77 offen offset:2048 sc1 lds
L_w3_14:
  s_waitcnt lgkmcnt(6)
  v_mfma_f32_32x32x16_bf16 v[192:207], a[240:243], a[32:35], v[192:207]
  ds_read_b64_tr_b16 a[232:233], v34 offset:4096
  ds_read_b64_tr_b16 a[234:235], v34 offset:4608
  v_xor_b32 v62, 0x800, v63
  v_mfma_f32_32x32x16_bf16 v[208:223], a[240:243], a[36:39], v[208:223]
  ds_read_b64_tr_b16 a[236:237], v36 offset:4096
  ds_read_b64_tr_b16 a[238:239], v36 offset:4608
  v_mfma_f32_32x32x16_bf16 v[224:239], a[244:247], a[32:35], v[224:239]
  s_add_u32 s60, s59, 65536
  buffer_load_dwordx2 v[2:3], v65, s[12:15], s60 offen sc1
  v_mfma_f32_32x32x16_bf16 v[240:255], a[244:247], a[36:39], v[240:255]
  s_add_u32 s60, s59, 82176
  buffer_load_dwordx2 v[4:5], v65, s[12:15], s60 offen sc1
  v_mfma_f32_16x16x32_bf16 v[84:87], v[80:83], a[240:243], v[84:87]
  v_mfma_f32_16x16x32_bf16 v[88:91], v[80:83], a[244:247], v[88:91]
  s_waitcnt lgkmcnt(5)
  v_mfma_f32_32x32x16_bf16 v[192:207], a[224:227], a[40:43], v[192:207]
  ds_read_b64_tr_b16 a[240:241], v35 offset:4096
  ds_read_b64_tr_b16 a[242:243], v35 offset:4608
  v_mfma_f32_32x32x16_bf16 v[208:223], a[224:227], a[44:47], v[208:223]
  ds_read_b64_tr_b16 a[244:245], v37 offset:4096
  ds_read_b64_tr_b16 a[246:247], v37 offset:4608
  v_mfma_f32_32x32x16_bf16 v[224:239], a[228:231], a[40:43], v[224:239]
  s_add_u32 s60, s59, 132096
  buffer_load_dwordx2 v[6:7], v65, s[12:15], s60 offen sc1
  v_mfma_f32_32x32x16_bf16 v[240:255], a[228:231], a[44:47], v[240:255]
  s_add_u32 s60, s59, 148736
  buffer_load_dwordx2 v[8:9], v65, s[12:15], s60 offen sc1
  s_waitcnt lgkmcnt(4)
  v_mfma_f32_32x32x16_bf16 v[192:207], a[232:235], a[48:51], v[192:207]
  v_mfma_f32_32x32x16_bf16 v[208:223], a[232:235], a[52:55], v[208:223]
  v_mfma_f32_32x32x16_bf16 v[224:239], a[236:239], a[48:51], v[224:239]
  v_mfma_f32_32x32x16_bf16 v[240:255], a[236:239], a[52:55], v[240:255]
  v_mfma_f32_16x16x32_bf16 v[84:87], v[80:83], a[232:235], v[84:87]
  v_mfma_f32_16x16x32_bf16 v[88:91], v[80:83], a[236:239], v[88:91]
  s_waitcnt lgkmcnt(0)
  v_mfma_f32_32x32x16_bf16 v[192:207], a[240:243], a[56:59], v[192:207]
  v_mfma_f32_32x32x16_bf16 v[208:223], a[240:243], a[60:63], v[208:223]
  v_mfma_f32_32x32x16_bf16 v[224:239], a[244:247], a[56:59], v[224:239]
  v_mfma_f32_32x32x16_bf16 v[240:255], a[244:247], a[60:63], v[240:255]
  s_branch L_join_9
.p2align 3
L_passC_8:
  s_waitcnt lgkmcnt(5)
  s_nop 4
  v_mfma_f32_32x32x16_bf16 v[192:207], a[240:243], a[64:67], 0
  ds_read_b64_tr_b16 a[232:233], v30 offset:36864
  ds_read_b64_tr_b16 a[234:235], v30 offset:37376
  v_mfma_f32_32x32x16_bf16 v[208:223], a[240:243], a[68:71], 0
  ds_read_b64_tr_b16 a[236:237], v32 offset:36864
  ds_read_b64_tr_b16 a[238:239], v32 offset:37376
  v_mfma_f32_32x32x16_bf16 v[224:239], a[244:247], a[64:67], 0
  buffer_load_dwordx4 v17, s[24:27], s93 offen offset:3072 lds
  v_mfma_f32_32x32x16_bf16 v[240:255], a[244:247], a[68:71], 0
  v_mfma_f32_16x16x32_bf16 v[84:87], v[80:83], a[240:243], 0
  v_mfma_f32_16x16x32_bf16 v[88:91], v[80:83], a[244:247], 0
  s_waitcnt lgkmcnt(5)
  v_mfma_f32_32x32x16_bf16 v[192:207], a[224:227], a[72:75], v[192:207]
  ds_read_b64_tr_b16 a[240:241], v31 offset:36864
  ds_read_b64_tr_b16 a[242:243], v31 offset:37376
  v_mfma_f32_32x32x16_bf16 v[208:223], a[224:227], a[76:79], v[208:223]
  ds_read_b64_tr_b16 a[244:245], v33 offset:36864
  ds_read_b64_tr_b16 a[246:247], v33 offset:37376
  v_mfma_f32_32x32x16_bf16 v[224:239], a[228:231], a[72:75], v[224:239]
  v_mfma_f32_32x32x16_bf16 v[240:255], a[228:231], a[76:79], v[240:255]
  s_waitcnt lgkmcnt(4)
  v_mfma_f32_32x32x16_bf16 v[192:207], a[232:235], a[80:83], v[192:207]
  s_barrier
  ds_read_b64_tr_b16 a[224:225], v30 offset:0
  ds_read_b64_tr_b16 a[226:227], v30 offset:512
  ds_read_b64 v[4:5], v67
  v_cmp_eq_u32 s[74:75], 0, v51
  v_mfma_f32_32x32x16_bf16 v[208:223], a[232:235], a[84:87], v[208:223]
  ds_read_b64_tr_b16 a[228:229], v32 offset:0
  ds_read_b64_tr_b16 a[230:231], v32 offset:512
  s_nop 0
  s_nop 0
  s_nop 0
  s_nop 0
  v_mfma_f32_32x32x16_bf16 v[224:239], a[236:239], a[80:83], v[224:239]
  s_add_u32 m0, s56, 65536
  s_mul_i32 s93, s49, 229376
  s_add_u32 s93, s93, s0
  buffer_load_dwordx4 v14, s[24:27], s93 offen offset:0 lds
  v_mfma_f32_32x32x16_bf16 v[240:255], a[236:239], a[84:87], v[240:255]
  buffer_load_dwordx4 v15, s[24:27], s93 offen offset:1024 lds
  s_waitcnt lgkmcnt(2)
  v_cndmask_b32 v65, v4, v2, s[74:75]
  v_cndmask_b32 v66, v5, v3, s[74:75]
  v_mfma_f32_16x16x32_bf16 v[84:87], v[80:83], a[232:235], v[84:87]
  v_and_b32 v63, 0xffff0000, v65
  v_sub_f32 v63, v65, v63
  v_mfma_f32_16x16x32_bf16 v[88:91], v[80:83], a[236:239], v[88:91]
  v_perm_b32 v2, v63, v65, s72
  v_mfma_f32_32x32x16_bf16 v[192:207], a[240:243], a[88:91], v[192:207]
  ds_read_b64_tr_b16 a[232:233], v31 offset:0
  ds_read_b64_tr_b16 a[234:235], v31 offset:512
  v_and_b32 v3, 0xffff0000, v63
  v_sub_f32 v63, v63, v3
  v_lshrrev_b32 v3, 16, v63
  v_mov_b32_e64 v4, 0
  v_mfma_f32_32x32x16_bf16 v[208:223], a[240:243], a[92:95], v[208:223]
  ds_read_b64_tr_b16 a[236:237], v33 offset:0
  ds_read_b64_tr_b16 a[238:239], v33 offset:512
  v_mov_b32_e64 v5, 0
  v_and_b32 v63, 0xffff0000, v66
  v_sub_f32_e64 v63, v66, v63
  v_perm_b32 v6, v63, v66, s72
  v_mfma_f32_32x32x16_bf16 v[224:239], a[244:247], a[88:91], v[224:239]
  buffer_load_dwordx4 v16, s[24:27], s93 offen offset:2048 lds
  v_and_b32 v7, 0xffff0000, v63
  v_sub_f32 v63, v63, v7
  v_lshrrev_b32 v7, 16, v63
  v_mfma_f32_32x32x16_bf16 v[240:255], a[244:247], a[92:95], v[240:255]
  v_mov_b32 v8, 0
  v_mov_b32_e64 v9, 0
  s_waitcnt lgkmcnt(4)
  v_mfma_f32_32x32x16_bf16 v[192:207], a[224:227], a[96:99], v[192:207]
  ds_read_b64_tr_b16 a[240:241], v30 offset:4096
  ds_read_b64_tr_b16 a[242:243], v30 offset:4608
  v_mfma_f32_32x32x16_bf16 v[128:143], v[2:5], v[18:21], v[128:143]
  v_mfma_f32_32x32x16_bf16 v[144:159], v[2:5], v[22:25], v[144:159]
  v_mfma_f32_32x32x16_bf16 v[160:175], v[6:9], v[18:21], v[160:175]
  v_mfma_f32_32x32x16_bf16 v[176:191], v[6:9], v[22:25], v[176:191]
  v_mfma_f32_32x32x16_bf16 v[208:223], a[224:227], a[100:103], v[208:223]
  ds_read_b64_tr_b16 a[244:245], v32 offset:4096
  ds_read_b64_tr_b16 a[246:247], v32 offset:4608
  s_nop 3
  s_nop 3
  v_mul_f32 v26, v128, v128
  v_mul_f32 v27, v129, v129
  v_mfma_f32_32x32x16_bf16 v[224:239], a[228:231], a[96:99], v[224:239]
  buffer_load_dwordx4 v17, s[24:27], s93 offen offset:3072 lds
  v_fma_f32 v26, v26, v56, v54
  v_fma_f32 v27, v27, v56, v54
  v_mul_f32_e64 v26, v26, v128
  v_mfma_f32_32x32x16_bf16 v[240:255], a[228:231], a[100:103], v[240:255]
  v_mul_f32 v27, v27, v129
  v_exp_f32 v26, v26
  v_exp_f32 v27, v27
  v_mul_f32 v128, v128, v136
  v_mfma_f32_16x16x32_bf16 v[84:87], v[80:83], a[224:227], v[84:87]
  v_mul_f32_e64 v129, v129, v137
  v_fma_f32 v26, v26, v58, v58
  v_mfma_f32_16x16x32_bf16 v[88:91], v[80:83], a[228:231], v[88:91]
  v_fma_f32 v27, v27, v58, v58
  s_waitcnt lgkmcnt(4)
  v_mfma_f32_32x32x16_bf16 v[192:207], a[232:235], a[104:107], v[192:207]
  ds_read_b64_tr_b16 a[224:225], v31 offset:4096
  ds_read_b64_tr_b16 a[226:227], v31 offset:4608
  v_rcp_f32 v26, v26
  v_rcp_f32_e64 v27, v27
  v_mfma_f32_32x32x16_bf16 v[208:223], a[232:235], a[108:111], v[208:223]
  ds_read_b64_tr_b16 a[228:229], v33 offset:4096
  ds_read_b64_tr_b16 a[230:231], v33 offset:4608
  v_mul_f32 v128, v128, v26
  v_mul_f32 v129, v129, v27
  v_cvt_pk_bf16_f32 v136, v128, v129
  v_mul_f32_e64 v28, v130, v130
  v_mfma_f32_32x32x16_bf16 v[224:239], a[236:239], a[104:107], v[224:239]
  v_mul_f32_e64 v29, v131, v131
  v_fma_f32 v28, v28, v56, v54
  v_fma_f32 v29, v29, v56, v54
  v_mul_f32 v28, v28, v130
  v_mul_f32 v29, v29, v131
  v_mfma_f32_32x32x16_bf16 v[240:255], a[236:239], a[108:111], v[240:255]
  v_exp_f32 v28, v28
  v_exp_f32 v29, v29
  v_mul_f32 v130, v130, v138
  s_waitcnt lgkmcnt(4)
  v_mfma_f32_32x32x16_bf16 v[192:207], a[240:243], a[112:115], v[192:207]
  s_barrier
  ds_read_b64_tr_b16 a[232:233], v30 offset:16384
  ds_read_b64_tr_b16 a[234:235], v30 offset:16896
  v_mul_f32 v131, v131, v139
  v_fma_f32 v28, v28, v58, v58
  v_mfma_f32_32x32x16_bf16 v[208:223], a[240:243], a[116:119], v[208:223]
  ds_read_b64_tr_b16 a[236:237], v32 offset:16384
  ds_read_b64_tr_b16 a[238:239], v32 offset:16896
  v_fma_f32 v29, v29, v58, v58
  v_rcp_f32_e64 v28, v28
  v_mfma_f32_32x32x16_bf16 v[224:239], a[244:247], a[112:115], v[224:239]
  s_add_u32 m0, s56, 32768
  s_add_u32 s93, s100, 0
  buffer_load_dwordx4 v74, s[36:39], s93 offen offset:0 lds
  v_mfma_f32_32x32x16_bf16 v[240:255], a[244:247], a[116:119], v[240:255]
  buffer_load_dwordx4 v75, s[36:39], s93 offen offset:1024 lds
  v_rcp_f32 v29, v29
  v_mul_f32_e64 v130, v130, v28
  v_mfma_f32_16x16x32_bf16 v[84:87], v[80:83], a[240:243], v[84:87]
  v_mul_f32_e64 v131, v131, v29
  v_cvt_pk_bf16_f32 v137, v130, v131
  v_mfma_f32_16x16x32_bf16 v[88:91], v[80:83], a[244:247], v[88:91]
  v_mul_f32 v26, v132, v132
  s_waitcnt lgkmcnt(4)
  v_mfma_f32_32x32x16_bf16 v[192:207], a[224:227], a[120:123], v[192:207]
  ds_read_b64_tr_b16 a[240:241], v31 offset:16384
  ds_read_b64_tr_b16 a[242:243], v31 offset:16896
  v_mul_f32_e64 v27, v133, v133
  v_fma_f32 v26, v26, v56, v54
  v_fma_f32 v27, v27, v56, v54
  v_mul_f32_e64 v26, v26, v132
  v_mfma_f32_32x32x16_bf16 v[208:223], a[224:227], a[124:127], v[208:223]
  ds_read_b64_tr_b16 a[244:245], v33 offset:16384
  ds_read_b64_tr_b16 a[246:247], v33 offset:16896
  v_mul_f32 v27, v27, v133
  v_exp_f32 v26, v26
  v_mfma_f32_32x32x16_bf16 v[224:239], a[228:231], a[120:123], v[224:239]
  buffer_load_dwordx4 v76, s[36:39], s93 offen offset:2048 lds
  v_exp_f32 v27, v27
  v_mul_f32 v132, v132, v140
  v_mfma_f32_32x32x16_bf16 v[240:255], a[228:231], a[124:127], v[240:255]
  v_mul_f32_e64 v133, v133, v141
  v_fma_f32 v26, v26, v58, v58
  v_fma_f32 v27, v27, v58, v58
  v_rcp_f32 v26, v26
  s_waitcnt lgkmcnt(4)
  v_mfma_f32_32x32x16_bf16 v[192:207], a[232:235], a[128:131], v[192:207]
  ds_read_b64_tr_b16 a[224:225], v30 offset:20480
  ds_read_b64_tr_b16 a[226:227], v30 offset:20992
  v_rcp_f32 v27, v27
  v_mul_f32 v132, v132, v26
  v_mul_f32_e64 v133, v133, v27
  v_mfma_f32_32x32x16_bf16 v[208:223], a[232:235], a[132:135], v[208:223]
  ds_read_b64_tr_b16 a[228:229], v32 offset:20480
  ds_read_b64_tr_b16 a[230:231], v32 offset:20992
  v_cvt_pk_bf16_f32 v138, v132, v133
  v_mul_f32 v28, v134, v134
  v_mul_f32 v29, v135, v135
  v_fma_f32 v28, v28, v56, v54
  v_mfma_f32_32x32x16_bf16 v[224:239], a[236:239], a[128:131], v[224:239]
  buffer_load_dwordx4 v77, s[36:39], s93 offen offset:3072 lds
  v_fma_f32 v29, v29, v56, v54
  v_mul_f32 v28, v28, v134
  v_mul_f32 v29, v29, v135
  v_mfma_f32_32x32x16_bf16 v[240:255], a[236:239], a[132:135], v[240:255]
  v_exp_f32 v28, v28
  v_exp_f32 v29, v29
  v_mul_f32 v134, v134, v142
  v_mul_f32 v135, v135, v143
  v_mfma_f32_16x16x32_bf16 v[84:87], v[80:83], a[232:235], v[84:87]
  v_fma_f32 v28, v28, v58, v58
  v_fma_f32 v29, v29, v58, v58
  v_mfma_f32_16x16x32_bf16 v[88:91], v[80:83], a[236:239], v[88:91]
  s_waitcnt lgkmcnt(4)
  v_mfma_f32_32x32x16_bf16 v[192:207], a[240:243], a[136:139], v[192:207]
  ds_read_b64_tr_b16 a[232:233], v31 offset:20480
  ds_read_b64_tr_b16 a[234:235], v31 offset:20992
  v_rcp_f32 v28, v28
  v_rcp_f32_e64 v29, v29
  v_mfma_f32_32x32x16_bf16 v[208:223], a[240:243], a[140:143], v[208:223]
  ds_read_b64_tr_b16 a[236:237], v33 offset:20480
  ds_read_b64_tr_b16 a[238:239], v33 offset:20992
  v_mul_f32 v134, v134, v28
  v_mul_f32 v135, v135, v29
  v_cvt_pk_bf16_f32 v139, v134, v135
  v_mfma_f32_32x32x16_bf16 v[224:239], a[244:247], a[136:139], v[224:239]
  buffer_store_dwordx4 v[136:139], v50, s[12:15], s96 offen offset:0 sc1
  v_mul_f32 v26, v144, v144
  v_mul_f32 v27, v145, v145
  v_fma_f32 v26, v26, v57, v55
  v_mfma_f32_32x32x16_bf16 v[240:255], a[244:247], a[140:143], v[240:255]
  v_fma_f32 v27, v27, v57, v55
  v_mul_f32 v26, v26, v144
  v_mul_f32 v27, v27, v145
  v_exp_f32 v26, v26
  s_waitcnt lgkmcnt(4)
  v_mfma_f32_32x32x16_bf16 v[192:207], a[224:227], a[144:147], v[192:207]
  s_barrier
  ds_read_b64_tr_b16 a[240:241], v30 offset:49152
  ds_read_b64_tr_b16 a[242:243], v30 offset:49664
  v_exp_f32 v27, v27
  v_mfma_f32_32x32x16_bf16 v[208:223], a[224:227], a[148:151], v[208:223]
  ds_read_b64_tr_b16 a[244:245], v32 offset:49152
  ds_read_b64_tr_b16 a[246:247], v32 offset:49664
  v_mul_f32 v144, v144, v152
  v_mul_f32 v145, v145, v153
  v_fma_f32 v26, v26, v59, v59
  v_fma_f32 v27, v27, v59, v59
  v_mfma_f32_32x32x16_bf16 v[224:239], a[228:231], a[144:147], v[224:239]
  s_add_u32 m0, s56, 0
  s_add_u32 s93, s100, 28672
  buffer_load_dwordx4 v74, s[36:39], s93 offen offset:0 lds
  v_mfma_f32_32x32x16_bf16 v[240:255], a[228:231], a[148:151], v[240:255]
  buffer_load_dwordx4 v75, s[36:39], s93 offen offset:1024 lds
  v_rcp_f32 v26, v26
  v_mfma_f32_16x16x32_bf16 v[84:87], v[80:83], a[224:227], v[84:87]
  v_rcp_f32_e64 v27, v27
  v_mfma_f32_16x16x32_bf16 v[88:91], v[80:83], a[228:231], v[88:91]
  v_mul_f32 v144, v144, v26
  s_waitcnt lgkmcnt(4)
  v_mfma_f32_32x32x16_bf16 v[192:207], a[232:235], a[152:155], v[192:207]
  ds_read_b64_tr_b16 a[224:225], v31 offset:49152
  ds_read_b64_tr_b16 a[226:227], v31 offset:49664
  v_mul_f32_e64 v145, v145, v27
  v_cvt_pk_bf16_f32 v152, v144, v145
  v_mul_f32 v28, v146, v146
  v_mul_f32 v29, v147, v147
  v_mfma_f32_32x32x16_bf16 v[208:223], a[232:235], a[156:159], v[208:223]
  ds_read_b64_tr_b16 a[228:229], v33 offset:49152
  ds_read_b64_tr_b16 a[230:231], v33 offset:49664
  v_fma_f32 v28, v28, v57, v55
  v_fma_f32 v29, v29, v57, v55
  v_mul_f32 v28, v28, v146
  v_mul_f32 v29, v29, v147
  v_mfma_f32_32x32x16_bf16 v[224:239], a[236:239], a[152:155], v[224:239]
  buffer_load_dwordx4 v76, s[36:39], s93 offen offset:2048 lds
  v_exp_f32_e64 v28, v28
  v_mfma_f32_32x32x16_bf16 v[240:255], a[236:239], a[156:159], v[240:255]
  v_exp_f32 v29, v29
  v_mul_f32 v146, v146, v154
  v_mul_f32_e64 v147, v147, v155
  v_fma_f32 v28, v28, v59, v59
  s_waitcnt lgkmcnt(4)
  v_mfma_f32_32x32x16_bf16 v[192:207], a[240:243], a[160:163], v[192:207]
  ds_read_b64_tr_b16 a[232:233], v30 offset:53248
  ds_read_b64_tr_b16 a[234:235], v30 offset:53760
  s_cmp_lg_u32 s3, 0
  s_cbranch_scc1 L_pw_17
  s_load_dwordx2 s[20:21], s[64:65], 0 glc
L_pw_17:
  s_mul_i32 s74, s5, 7
  s_add_u32 s74, s74, s3
  s_mul_i32 s74, s74, 16640
  v_mfma_f32_32x32x16_bf16 v[208:223], a[240:243], a[164:167], v[208:223]
  ds_read_b64_tr_b16 a[236:237], v32 offset:53248
  ds_read_b64_tr_b16 a[238:239], v32 offset:53760
  s_lshl_b32 s75, s4, 10
  s_add_u32 s74, s74, s75
  s_mul_i32 s75, s3, 3072
  s_mul_i32 s76, s3, 3104
  v_mfma_f32_32x32x16_bf16 v[224:239], a[244:247], a[160:163], v[224:239]
  buffer_load_dwordx4 v77, s[36:39], s93 offen offset:3072 lds
  s_mul_i32 s59, s5, 116480
  s_lshl2_add_u32 s60, s4, s3
  s_lshl_b32 s60, s60, 8
  v_mfma_f32_32x32x16_bf16 v[240:255], a[244:247], a[164:167], v[240:255]
  s_add_u32 s59, s59, s60
  v_mul_u32_u24 v65, 33280, v51
  v_lshl_add_u32 v65, v53, 3, v65
  v_fma_f32 v29, v29, v59, v59
  v_rcp_f32_e64 v28, v28
  v_mfma_f32_16x16x32_bf16 v[84:87], v[80:83], a[240:243], v[84:87]
  v_rcp_f32_e64 v29, v29
  v_mfma_f32_16x16x32_bf16 v[88:91], v[80:83], a[244:247], v[88:91]
  v_mul_f32 v146, v146, v28
  s_waitcnt lgkmcnt(4)
  v_mfma_f32_32x32x16_bf16 v[192:207], a[224:227], a[168:171], v[192:207]
  ds_read_b64_tr_b16 a[240:241], v31 offset:53248
  ds_read_b64_tr_b16 a[242:243], v31 offset:53760
  v_mul_f32_e64 v147, v147, v29
  v_cvt_pk_bf16_f32 v153, v146, v147
  v_mul_f32 v26, v148, v148
  v_mul_f32 v27, v149, v149
  v_mfma_f32_32x32x16_bf16 v[208:223], a[224:227], a[172:175], v[208:223]
  ds_read_b64_tr_b16 a[244:245], v33 offset:53248
  ds_read_b64_tr_b16 a[246:247], v33 offset:53760
  v_fma_f32 v26, v26, v57, v55
  v_fma_f32 v27, v27, v57, v55
  v_mul_f32 v26, v26, v148
  v_mul_f32 v27, v27, v149
  v_mfma_f32_32x32x16_bf16 v[224:239], a[228:231], a[168:171], v[224:239]
  v_exp_f32 v26, v26
  v_exp_f32 v27, v27
  v_mul_f32 v148, v148, v156
  v_mul_f32 v149, v149, v157
  v_mfma_f32_32x32x16_bf16 v[240:255], a[228:231], a[172:175], v[240:255]
  v_fma_f32 v26, v26, v59, v59
  v_fma_f32 v27, v27, v59, v59
  v_rcp_f32 v26, v26
  s_waitcnt lgkmcnt(4)
  v_mfma_f32_32x32x16_bf16 v[192:207], a[232:235], a[176:179], v[192:207]
  s_waitcnt vmcnt(18)
  s_barrier
  ds_read_b64_tr_b16 a[224:225], v34 offset:32768
  ds_read_b64_tr_b16 a[226:227], v34 offset:33280
  v_rcp_f32_e64 v27, v27
  v_mfma_f32_32x32x16_bf16 v[208:223], a[232:235], a[180:183], v[208:223]
  ds_read_b64_tr_b16 a[228:229], v36 offset:32768
  ds_read_b64_tr_b16 a[230:231], v36 offset:33280
  v_mul_f32 v148, v148, v26
  v_mul_f32 v149, v149, v27
  v_cvt_pk_bf16_f32 v154, v148, v149
  v_mul_f32_e64 v28, v150, v150
  v_mfma_f32_32x32x16_bf16 v[224:239], a[236:239], a[176:179], v[224:239]
  s_add_u32 m0, s56, 16384
  s_add_u32 s93, s100, 114688
  buffer_load_dwordx4 v74, s[36:39], s93 offen offset:0 lds
  v_mul_f32_e64 v29, v151, v151
  v_mfma_f32_32x32x16_bf16 v[240:255], a[236:239], a[180:183], v[240:255]
  buffer_load_dwordx4 v75, s[36:39], s93 offen offset:1024 lds
  v_fma_f32 v28, v28, v57, v55
  v_fma_f32 v29, v29, v57, v55
  v_mul_f32_e64 v28, v28, v150
  v_mfma_f32_16x16x32_bf16 v[84:87], v[80:83], a[232:235], v[84:87]
  v_mul_f32_e64 v29, v29, v151
  v_mfma_f32_16x16x32_bf16 v[88:91], v[80:83], a[236:239], v[88:91]
  s_waitcnt lgkmcnt(4)
  v_mfma_f32_32x32x16_bf16 v[192:207], a[240:243], a[184:187], v[192:207]
  ds_read_b64_tr_b16 a[232:233], v35 offset:32768
  ds_read_b64_tr_b16 a[234:235], v35 offset:33280
  v_exp_f32 v28, v28
  v_exp_f32_e64 v29, v29
  v_mfma_f32_32x32x16_bf16 v[208:223], a[240:243], a[188:191], v[208:223]
  ds_read_b64_tr_b16 a[236:237], v37 offset:32768
  ds_read_b64_tr_b16 a[238:239], v37 offset:33280
  v_mul_f32 v150, v150, v158
  v_mul_f32 v151, v151, v159
  v_fma_f32 v28, v28, v59, v59
  v_fma_f32 v29, v29, v59, v59
  v_mfma_f32_32x32x16_bf16 v[224:239], a[244:247], a[184:187], v[224:239]
  buffer_load_dwordx4 v76, s[36:39], s93 offen offset:2048 lds
  v_rcp_f32_e64 v28, v28
  v_mfma_f32_32x32x16_bf16 v[240:255], a[244:247], a[188:191], v[240:255]
  v_rcp_f32 v29, v29
  v_mul_f32 v150, v150, v28
  v_mul_f32_e64 v151, v151, v29
  v_cvt_pk_bf16_f32 v155, v150, v151
  s_waitcnt lgkmcnt(4)
  v_mfma_f32_32x32x16_bf16 v[192:207], a[224:227], a[192:195], v[192:207]
  ds_read_b64_tr_b16 a[240:241], v34 offset:36864
  ds_read_b64_tr_b16 a[242:243], v34 offset:37376
  buffer_store_dwordx4 v[152:155], v50, s[12:15], s97 offen offset:0 sc1
  v_mul_f32 v26, v160, v160
  v_mfma_f32_32x32x16_bf16 v[208:223], a[224:227], a[196:199], v[208:223]
  ds_read_b64_tr_b16 a[244:245], v36 offset:36864
  ds_read_b64_tr_b16 a[246:247], v36 offset:37376
  v_mul_f32_e64 v27, v161, v161
  v_fma_f32 v26, v26, v56, v54
  v_fma_f32 v27, v27, v56, v54
  v_mul_f32_e64 v26, v26, v160
  v_mfma_f32_32x32x16_bf16 v[224:239], a[228:231], a[192:195], v[224:239]
  buffer_load_dwordx4 v77, s[36:39], s93 offen offset:3072 lds
  v_mul_f32 v27, v27, v161
  v_exp_f32 v26, v26
  v_mfma_f32_32x32x16_bf16 v[240:255], a[228:231], a[196:199], v[240:255]
  v_exp_f32 v27, v27
  v_mul_f32 v160, v160, v168
  v_mul_f32_e64 v161, v161, v169
  v_fma_f32 v26, v26, v58, v58
  v_fma_f32 v27, v27, v58, v58
  v_mfma_f32_16x16x32_bf16 v[84:87], v[80:83], a[224:227], v[84:87]
  v_rcp_f32_e64 v26, v26
  v_mfma_f32_16x16x32_bf16 v[88:91], v[80:83], a[228:231], v[88:91]
  s_waitcnt lgkmcnt(4)
  v_mfma_f32_32x32x16_bf16 v[192:207], a[232:235], a[200:203], v[192:207]
  ds_read_b64_tr_b16 a[224:225], v35 offset:36864
  ds_read_b64_tr_b16 a[226:227], v35 offset:37376
  v_rcp_f32 v27, v27
  v_mul_f32 v160, v160, v26
  v_mul_f32 v161, v161, v27
  v_mfma_f32_32x32x16_bf16 v[208:223], a[232:235], a[204:207], v[208:223]
  ds_read_b64_tr_b16 a[228:229], v37 offset:36864
  ds_read_b64_tr_b16 a[230:231], v37 offset:37376
  v_cvt_pk_bf16_f32 v168, v160, v161
  v_mul_f32 v28, v162, v162
  v_mul_f32 v29, v163, v163
  v_fma_f32 v28, v28, v56, v54
  v_mfma_f32_32x32x16_bf16 v[224:239], a[236:239], a[200:203], v[224:239]
  v_fma_f32 v29, v29, v56, v54
  v_mul_f32 v28, v28, v162
  v_mul_f32 v29, v29, v163
  v_exp_f32_e64 v28, v28
  v_mfma_f32_32x32x16_bf16 v[240:255], a[236:239], a[204:207], v[240:255]
  v_exp_f32 v29, v29
  v_mul_f32 v162, v162, v170
  v_mul_f32_e64 v163, v163, v171
  v_fma_f32 v28, v28, v58, v58
  s_waitcnt lgkmcnt(4)
  v_mfma_f32_32x32x16_bf16 v[192:207], a[240:243], a[208:211], v[192:207]
  s_waitcnt vmcnt(18)
  s_barrier
  ds_read_b64_tr_b16 a[232:233], v34 offset:16384
  ds_read_b64_tr_b16 a[234:235], v34 offset:16896
  v_fma_f32 v29, v29, v58, v58
  v_mfma_f32_32x32x16_bf16 v[208:223], a[240:243], a[212:215], v[208:223]
  ds_read_b64_tr_b16 a[236:237], v36 offset:16384
  ds_read_b64_tr_b16 a[238:239], v36 offset:16896
  v_rcp_f32 v28, v28
  v_rcp_f32_e64 v29, v29
  v_mfma_f32_32x32x16_bf16 v[224:239], a[244:247], a[208:211], v[224:239]
  s_add_u32 m0, s56, 49152
  s_add_u32 s93, s100, 143360
  buffer_load_dwordx4 v74, s[36:39], s93 offen offset:0 lds
  v_mul_f32_e64 v162, v162, v28
  v_mfma_f32_32x32x16_bf16 v[240:255], a[244:247], a[212:215], v[240:255]
  buffer_load_dwordx4 v75, s[36:39], s93 offen offset:1024 lds
  v_mul_f32_e64 v163, v163, v29
  v_cvt_pk_bf16_f32 v169, v162, v163
  v_mul_f32_e64 v26, v164, v164
  v_mfma_f32_16x16x32_bf16 v[84:87], v[80:83], a[240:243], v[84:87]
  v_mul_f32_e64 v27, v165, v165
  v_fma_f32 v26, v26, v56, v54
  v_mfma_f32_16x16x32_bf16 v[88:91], v[80:83], a[244:247], v[88:91]
  v_fma_f32 v27, v27, v56, v54
  s_waitcnt lgkmcnt(4)
  v_mfma_f32_32x32x16_bf16 v[192:207], a[224:227], a[216:219], v[192:207]
  ds_read_b64_tr_b16 a[240:241], v35 offset:16384
  ds_read_b64_tr_b16 a[242:243], v35 offset:16896
  v_mul_f32 v26, v26, v164
  v_mul_f32 v27, v27, v165
  v_exp_f32 v26, v26
  v_mfma_f32_32x32x16_bf16 v[208:223], a[224:227], a[220:223], v[208:223]
  ds_read_b64_tr_b16 a[244:245], v37 offset:16384
  ds_read_b64_tr_b16 a[246:247], v37 offset:16896
  v_exp_f32 v27, v27
  v_mul_f32 v164, v164, v172
  v_mul_f32_e64 v165, v165, v173
  v_mfma_f32_32x32x16_bf16 v[224:239], a[228:231], a[216:219], v[224:239]
  buffer_load_dwordx4 v76, s[36:39], s93 offen offset:2048 lds
  v_fma_f32 v26, v26, v58, v58
  v_fma_f32 v27, v27, v58, v58
  v_mfma_f32_32x32x16_bf16 v[240:255], a[228:231], a[220:223], v[240:255]
  v_rcp_f32 v26, v26
  v_rcp_f32 v27, v27
  v_mul_f32 v164, v164, v26
  s_waitcnt lgkmcnt(4)
  v_mfma_f32_32x32x16_bf16 v[192:207], a[232:235], a[0:3], v[192:207]
  ds_read_b64_tr_b16 a[224:225], v34 offset:20480
  ds_read_b64_tr_b16 a[226:227], v34 offset:20992
  v_mul_f32_e64 v165, v165, v27
  v_cvt_pk_bf16_f32 v170, v164, v165
  v_mul_f32 v28, v166, v166
  v_mul_f32 v29, v167, v167
  v_mfma_f32_32x32x16_bf16 v[208:223], a[232:235], a[4:7], v[208:223]
  ds_read_b64_tr_b16 a[228:229], v36 offset:20480
  ds_read_b64_tr_b16 a[230:231], v36 offset:20992
  v_fma_f32 v28, v28, v56, v54
  v_fma_f32 v29, v29, v56, v54
  v_mul_f32 v28, v28, v166
  v_mul_f32 v29, v29, v167
  v_mfma_f32_32x32x16_bf16 v[224:239], a[236:239], a[0:3], v[224:239]
  buffer_load_dwordx4 v77, s[36:39], s93 offen offset:3072 lds
  v_exp_f32_e64 v28, v28
  v_mfma_f32_32x32x16_bf16 v[240:255], a[236:239], a[4:7], v[240:255]
  v_exp_f32 v29, v29
  v_mul_f32 v166, v166, v174
  v_mul_f32_e64 v167, v167, v175
  v_fma_f32 v28, v28, v58, v58
  v_fma_f32 v29, v29, v58, v58
  v_mfma_f32_16x16x32_bf16 v[84:87], v[80:83], a[232:235], v[84:87]
  v_rcp_f32_e64 v28, v28
  v_mfma_f32_16x16x32_bf16 v[88:91], v[80:83], a[236:239], v[88:91]
  s_waitcnt lgkmcnt(4)
  v_mfma_f32_32x32x16_bf16 v[192:207], a[240:243], a[8:11], v[192:207]
  ds_read_b64_tr_b16 a[232:233], v35 offset:20480
  ds_read_b64_tr_b16 a[234:235], v35 offset:20992
  v_rcp_f32 v29, v29
  v_mul_f32 v166, v166, v28
  v_mul_f32 v167, v167, v29
  v_mfma_f32_32x32x16_bf16 v[208:223], a[240:243], a[12:15], v[208:223]
  ds_read_b64_tr_b16 a[236:237], v37 offset:20480
  ds_read_b64_tr_b16 a[238:239], v37 offset:20992
  v_cvt_pk_bf16_f32 v171, v166, v167
  buffer_store_dwordx4 v[168:171], v50, s[12:15], s96 offen offset:1024 sc1
  v_mfma_f32_32x32x16_bf16 v[224:239], a[244:247], a[8:11], v[224:239]
  v_mul_f32 v26, v176, v176
  v_mul_f32 v27, v177, v177
  v_fma_f32 v26, v26, v57, v55
  v_fma_f32 v27, v27, v57, v55
  v_mul_f32 v26, v26, v176
  v_mul_f32 v27, v27, v177
  v_mfma_f32_32x32x16_bf16 v[240:255], a[244:247], a[12:15], v[240:255]
  v_exp_f32 v26, v26
  v_exp_f32 v27, v27
  v_mul_f32 v176, v176, v184
  s_waitcnt lgkmcnt(4)
  v_mfma_f32_32x32x16_bf16 v[192:207], a[224:227], a[16:19], v[192:207]
  s_cmp_lg_u32 s3, 0
  s_cbranch_scc1 L_pw_18
  s_waitcnt lgkmcnt(0)
  s_andn2_b32 s20, s68, s20
  s_andn2_b32 s21, s73, s21
  s_or_b32 s20, s20, s21
  s_cmp_eq_u32 s20, 0
  s_cbranch_scc1 L_ok_15
  s_mov_b32 s94, 0
L_spin_16:
  s_sleep 4
  s_load_dwordx2 s[20:21], s[64:65], 0 glc
  s_add_u32 s94, s94, 1
  s_cmp_gt_u32 s94, 3145728
  s_cbranch_scc1 L_ok_15
  s_waitcnt lgkmcnt(0)
  s_andn2_b32 s20, s68, s20
  s_andn2_b32 s21, s73, s21
  s_or_b32 s20, s20, s21
  s_cmp_eq_u32 s20, 0
  s_cbranch_scc0 L_spin_16
L_ok_15:
L_pw_18:
  s_waitcnt vmcnt(19)
  s_barrier
  ds_read_b64_tr_b16 a[240:241], v34 offset:0
  ds_read_b64_tr_b16 a[242:243], v34 offset:512
  v_mul_f32_e64 v177, v177, v185
  v_fma_f32 v26, v26, v59, v59
  v_mfma_f32_32x32x16_bf16 v[208:223], a[224:227], a[20:23], v[208:223]
  ds_read_b64_tr_b16 a[244:245], v36 offset:0
  ds_read_b64_tr_b16 a[246:247], v36 offset:512
  v_fma_f32 v27, v27, v59, v59
  v_rcp_f32_e64 v26, v26
  v_mfma_f32_32x32x16_bf16 v[224:239], a[228:231], a[16:19], v[224:239]
  s_add_u32 m0, s75, 114688
  s_add_u32 s77, s74, 1927168
  buffer_load_dwordx4 v10, s[12:15], s77 offen offset:0 sc1 lds
  v_mfma_f32_32x32x16_bf16 v[240:255], a[228:231], a[20:23], v[240:255]
  buffer_load_dwordx4 v11, s[12:15], s77 offen offset:1024 sc1 lds
  v_rcp_f32 v27, v27
  v_mul_f32 v176, v176, v26
  v_mfma_f32_16x16x32_bf16 v[84:87], v[80:83], a[224:227], v[84:87]
  v_mul_f32_e64 v177, v177, v27
  v_cvt_pk_bf16_f32 v184, v176, v177
  v_mfma_f32_16x16x32_bf16 v[88:91], v[80:83], a[228:231], v[88:91]
  v_mul_f32 v28, v178, v178
  s_waitcnt lgkmcnt(4)
  v_mfma_f32_32x32x16_bf16 v[192:207], a[232:235], a[24:27], v[192:207]
  ds_read_b64_tr_b16 a[224:225], v35 offset:0
  ds_read_b64_tr_b16 a[226:227], v35 offset:512
  v_mul_f32_e64 v29, v179, v179
  v_fma_f32 v28, v28, v57, v55
  v_fma_f32 v29, v29, v57, v55
  v_mul_f32_e64 v28, v28, v178
  v_mfma_f32_32x32x16_bf16 v[208:223], a[232:235], a[28:31], v[208:223]
  ds_read_b64_tr_b16 a[228:229], v37 offset:0
  ds_read_b64_tr_b16 a[230:231], v37 offset:512
  v_mul_f32 v29, v29, v179
  v_exp_f32 v28, v28
  v_mfma_f32_32x32x16_bf16 v[224:239], a[236:239], a[24:27], v[224:239]
  buffer_load_dwordx4 v12, s[12:15], s77 offen offset:2048 sc1 lds
  v_exp_f32 v29, v29
  v_mul_f32 v178, v178, v186
  v_mfma_f32_32x32x16_bf16 v[240:255], a[236:239], a[28:31], v[240:255]
  s_cmp_eq_u32 s3, 3
  s_cbranch_scc1 L_w3_19
  s_add_u32 m0, s75, 126976
  s_add_u32 s77, s74, 1993728
  buffer_load_dwordx4 v10, s[12:15], s77 offen offset:0 sc1 lds
  buffer_load_dwordx4 v11, s[12:15], s77 offen offset:1024 sc1 lds
  buffer_load_dwordx4 v12, s[12:15], s77 offen offset:2048 sc1 lds
L_w3_19:
  s_waitcnt lgkmcnt(4)
  v_mfma_f32_32x32x16_bf16 v[192:207], a[240:243], a[32:35], v[192:207]
  ds_read_b64_tr_b16 a[232:233], v34 offset:4096
  ds_read_b64_tr_b16 a[234:235], v34 offset:4608
  v_mul_f32 v179, v179, v187
  v_fma_f32 v28, v28, v59, v59
  v_fma_f32 v29, v29, v59, v59
  v_mfma_f32_32x32x16_bf16 v[208:223], a[240:243], a[36:39], v[208:223]
  ds_read_b64_tr_b16 a[236:237], v36 offset:4096
  ds_read_b64_tr_b16 a[238:239], v36 offset:4608
  v_rcp_f32 v28, v28
  v_rcp_f32 v29, v29
  v_mfma_f32_32x32x16_bf16 v[224:239], a[244:247], a[32:35], v[224:239]
  s_add_u32 s60, s59, 65536
  buffer_load_dwordx2 v[2:3], v65, s[12:15], s60 offen sc1
  v_mul_f32 v178, v178, v28
  v_mul_f32 v179, v179, v29
  v_mfma_f32_32x32x16_bf16 v[240:255], a[244:247], a[36:39], v[240:255]
  s_add_u32 s60, s59, 82176
  buffer_load_dwordx2 v[4:5], v65, s[12:15], s60 offen sc1
  v_cvt_pk_bf16_f32 v185, v178, v179
  v_mul_f32_e64 v26, v180, v180
  v_mfma_f32_16x16x32_bf16 v[84:87], v[80:83], a[240:243], v[84:87]
  v_mul_f32_e64 v27, v181, v181
  v_fma_f32 v26, v26, v57, v55
  v_mfma_f32_16x16x32_bf16 v[88:91], v[80:83], a[244:247], v[88:91]
  v_fma_f32 v27, v27, v57, v55
  s_waitcnt lgkmcnt(4)
  v_mfma_f32_32x32x16_bf16 v[192:207], a[224:227], a[40:43], v[192:207]
  ds_read_b64_tr_b16 a[240:241], v35 offset:4096
  ds_read_b64_tr_b16 a[242:243], v35 offset:4608
  v_mul_f32 v26, v26, v180
  v_mul_f32 v27, v27, v181
  v_exp_f32 v26, v26
  v_mfma_f32_32x32x16_bf16 v[208:223], a[224:227], a[44:47], v[208:223]
  ds_read_b64_tr_b16 a[244:245], v37 offset:4096
  ds_read_b64_tr_b16 a[246:247], v37 offset:4608
  v_exp_f32 v27, v27
  v_mul_f32 v180, v180, v188
  v_mul_f32_e64 v181, v181, v189
  v_mfma_f32_32x32x16_bf16 v[224:239], a[228:231], a[40:43], v[224:239]
  s_add_u32 s60, s59, 132096
  buffer_load_dwordx2 v[6:7], v65, s[12:15], s60 offen sc1
  v_fma_f32 v26, v26, v59, v59
  v_fma_f32 v27, v27, v59, v59
  v_mfma_f32_32x32x16_bf16 v[240:255], a[228:231], a[44:47], v[240:255]
  s_add_u32 s60, s59, 148736
  buffer_load_dwordx2 v[8:9], v65, s[12:15], s60 offen sc1
  s_waitcnt lgkmcnt(4)
  v_mfma_f32_32x32x16_bf16 v[192:207], a[232:235], a[48:51], v[192:207]
  v_rcp_f32 v26, v26
  v_rcp_f32 v27, v27
  v_mul_f32 v180, v180, v26
  v_mul_f32_e64 v181, v181, v27
  v_mfma_f32_32x32x16_bf16 v[208:223], a[232:235], a[52:55], v[208:223]
  v_cvt_pk_bf16_f32 v186, v180, v181
  v_mul_f32 v28, v182, v182
  v_mul_f32 v29, v183, v183
  v_fma_f32 v28, v28, v57, v55
  v_fma_f32 v29, v29, v57, v55
  v_mul_f32_e64 v28, v28, v182
  v_mfma_f32_32x32x16_bf16 v[224:239], a[236:239], a[48:51], v[224:239]
  v_mul_f32 v29, v29, v183
  v_exp_f32 v28, v28
  v_exp_f32 v29, v29
  v_mul_f32 v182, v182, v190
  v_mfma_f32_32x32x16_bf16 v[240:255], a[236:239], a[52:55], v[240:255]
  v_mul_f32_e64 v183, v183, v191
  v_fma_f32 v28, v28, v59, v59
  v_fma_f32 v29, v29, v59, v59
  v_rcp_f32_e64 v28, v28
  v_mfma_f32_16x16x32_bf16 v[84:87], v[80:83], a[232:235], v[84:87]
  v_rcp_f32_e64 v29, v29
  v_mfma_f32_16x16x32_bf16 v[88:91], v[80:83], a[236:239], v[88:91]
  v_mul_f32 v182, v182, v28
  s_waitcnt lgkmcnt(0)
  v_mfma_f32_32x32x16_bf16 v[192:207], a[240:243], a[56:59], v[192:207]
  v_mul_f32_e64 v183, v183, v29
  v_cvt_pk_bf16_f32 v187, v182, v183
  buffer_store_dwordx4 v[184:187], v50, s[12:15], s97 offen offset:1024 sc1
  v_min_u32 v62, 191, v0
  v_mfma_f32_32x32x16_bf16 v[208:223], a[240:243], a[60:63], v[208:223]
  s_lshl_b32 s79, s4, 6
  v_add_u32 v66, s79, v62
  v_mov_b32 v67, 0xf14a
  v_cmp_gt_u32 vcc, 128, v66
  v_mov_b32 v129, 0
  v_mov_b32 v131, 0
  v_mfma_f32_32x32x16_bf16 v[224:239], a[244:247], a[56:59], v[224:239]
  v_cndmask_b32 v128, 0, v67, vcc
  v_cndmask_b32 v130, 0, v67, vcc
  v_lshlrev_b32_e64 v62, 4, v62
  v_add_u32 v62, 136192, v62
  ds_write_b128 v62, v[128:131]
  v_min_u32 v66, 147, v0
  v_mfma_f32_32x32x16_bf16 v[240:255], a[244:247], a[60:63], v[240:255]
  v_lshlrev_b32_e64 v66, 4, v66
  v_add_u32 v66, 160992, v66
  v_mov_b32 v132, 0x3f803f80
  v_mov_b32 v133, 0x3f803f80
  v_mov_b32 v134, 0x3f803f80
  v_mov_b32 v135, 0x3f803f80
  ds_write_b128 v66, v[132:135]
  s_lshl_b32 s79, s3, 11
  v_lshlrev_b32 v63, 3, v1
  v_add_u32_e64 v63, s79, v63
  v_add_u32 v63, 98304, v63
  v_xor_b32 v62, 0x800, v63
L_join_9:
  s_waitcnt lgkmcnt(0)
  v_mov_b32 v85, v88
  ds_write_b64 v63, v[84:85]
  v_cmp_eq_u32_e64 vcc, 0, v51
  s_waitcnt lgkmcnt(0)
  s_waitcnt vmcnt(19)
  ds_read_b64_tr_b16 a[0:1], v44 offset:32768
  ds_read_b64_tr_b16 a[2:3], v44 offset:33792
  ds_read_b64_tr_b16 a[4:5], v45 offset:32768
  ds_read_b64_tr_b16 a[6:7], v45 offset:33792
  ds_read_b64_tr_b16 a[8:9], v44 offset:34816
  ds_read_b64_tr_b16 a[10:11], v44 offset:35840
  ds_read_b64_tr_b16 a[12:13], v45 offset:34816
  ds_read_b64_tr_b16 a[14:15], v45 offset:35840
  s_barrier
  ds_read_b64 v[86:87], v62
  s_waitcnt vmcnt(15)
  ds_read_b64_tr_b16 a[16:17], v44 offset:0
  ds_read_b64_tr_b16 a[18:19], v44 offset:1024
  ds_read_b64_tr_b16 a[20:21], v45 offset:0
  ds_read_b64_tr_b16 a[22:23], v45 offset:1024
  ds_read_b64_tr_b16 a[24:25], v44 offset:2048
  ds_read_b64_tr_b16 a[26:27], v44 offset:3072
  ds_read_b64_tr_b16 a[28:29], v45 offset:2048
  ds_read_b64_tr_b16 a[30:31], v45 offset:3072
  s_add_u32 m0, s56, 81920
  s_add_u32 s93, s100, 229376
  buffer_load_dwordx4 v74, s[36:39], s93 offen offset:0 lds
  s_waitcnt lgkmcnt(8)
  v_cndmask_b32 v63, v86, v84, vcc
  v_cndmask_b32_e64 v64, v87, v85, vcc
  v_and_b32 v67, 0xffff0000, v63
  v_sub_f32_e64 v67, v63, v67
  v_perm_b32 v84, v67, v63, s72
  v_and_b32 v85, 0xffff0000, v67
  v_sub_f32 v67, v67, v85
  v_lshrrev_b32 v85, 16, v67
  v_mov_b32 v86, 0
  v_mov_b32_e64 v87, 0
  s_nop 1
  v_mfma_f32_32x32x16_bf16 v[192:207], v[84:87], v[18:21], v[192:207]
  v_and_b32 v67, 0xffff0000, v64
  v_sub_f32_e64 v67, v64, v67
  v_perm_b32 v88, v67, v64, s72
  v_and_b32 v89, 0xffff0000, v67
  v_sub_f32_e64 v67, v67, v89
  v_mfma_f32_32x32x16_bf16 v[208:223], v[84:87], v[22:25], v[208:223]
  v_lshrrev_b32 v89, 16, v67
  v_mov_b32 v90, 0
  v_mov_b32 v91, 0
  s_lshl1_add_u32 s57, s4, s6
  s_mul_i32 s57, s57, 112
  v_mfma_f32_32x32x16_bf16 v[224:239], v[88:91], v[18:21], v[224:239]
  s_lshl1_add_u32 s58, s63, s7
  s_add_u32 s57, s57, s58
  s_lshl_b32 s57, s57, 11
  s_add_u32 s96, s57, 8388608
  s_add_u32 s97, s96, 114688
  v_mfma_f32_32x32x16_bf16 v[240:255], v[88:91], v[22:25], v[240:255]
  buffer_load_dwordx4 v75, s[36:39], s93 offen offset:1024 lds
  s_waitcnt vmcnt(13)
  ds_read_b64_tr_b16 a[32:33], v44 offset:16384
  ds_read_b64_tr_b16 a[34:35], v44 offset:17408
  ds_read_b64_tr_b16 a[36:37], v45 offset:16384
  ds_read_b64_tr_b16 a[38:39], v45 offset:17408
  ds_read_b64_tr_b16 a[40:41], v44 offset:18432
  ds_read_b64_tr_b16 a[42:43], v44 offset:19456
  ds_read_b64_tr_b16 a[44:45], v45 offset:18432
  ds_read_b64_tr_b16 a[46:47], v45 offset:19456
  buffer_load_dwordx4 v76, s[36:39], s93 offen offset:2048 lds
  s_waitcnt vmcnt(10)
  ds_read_b64_tr_b16 a[48:49], v44 offset:49152
  ds_read_b64_tr_b16 a[50:51], v44 offset:50176
  ds_read_b64_tr_b16 a[52:53], v45 offset:49152
  ds_read_b64_tr_b16 a[54:55], v45 offset:50176
  ds_read_b64_tr_b16 a[56:57], v44 offset:51200
  ds_read_b64_tr_b16 a[58:59], v44 offset:52224
  ds_read_b64_tr_b16 a[60:61], v45 offset:51200
  ds_read_b64_tr_b16 a[62:63], v45 offset:52224
  buffer_load_dwordx4 v77, s[36:39], s93 offen offset:3072 lds
  v_pk_mul_f32 v[128:129], v[192:193], v[192:193]
  v_pk_mul_f32 v[130:131], v[194:195], v[194:195]
  v_pk_mul_f32 v[132:133], v[196:197], v[196:197]
  v_pk_mul_f32 v[134:135], v[198:199], v[198:199]
  v_pk_fma_f32 v[128:129], v[128:129], v[56:57], v[54:55] op_sel_hi:[1,0,0]
  v_pk_fma_f32 v[130:131], v[130:131], v[56:57], v[54:55] op_sel_hi:[1,0,0]
  v_pk_fma_f32 v[132:133], v[132:133], v[56:57], v[54:55] op_sel_hi:[1,0,0]
  v_pk_fma_f32 v[134:135], v[134:135], v[56:57], v[54:55] op_sel_hi:[1,0,0]
  v_pk_mul_f32 v[128:129], v[128:129], v[192:193]
  v_pk_mul_f32 v[130:131], v[130:131], v[194:195]
  v_pk_mul_f32 v[132:133], v[132:133], v[196:197]
  v_pk_mul_f32 v[134:135], v[134:135], v[198:199]
  v_exp_f32 v128, v128
  v_exp_f32 v129, v129
  v_exp_f32 v130, v130
  v_exp_f32_e64 v131, v131
  s_add_u32 m0, s56, 65536
  s_add_u32 s93, s100, 258048
  buffer_load_dwordx4 v74, s[36:39], s93 offen offset:0 lds
  v_exp_f32 v132, v132
  v_exp_f32 v133, v133
  v_exp_f32 v134, v134
  v_exp_f32 v135, v135
  v_pk_mul_f32 v[192:193], v[192:193], v[200:201]
  v_pk_mul_f32 v[194:195], v[194:195], v[202:203]
  v_pk_mul_f32 v[196:197], v[196:197], v[204:205]
  v_pk_mul_f32 v[198:199], v[198:199], v[206:207]
  v_pk_fma_f32 v[128:129], v[128:129], v[58:59], v[58:59] op_sel_hi:[1,0,0]
  v_pk_fma_f32 v[130:131], v[130:131], v[58:59], v[58:59] op_sel_hi:[1,0,0]
  v_pk_fma_f32 v[132:133], v[132:133], v[58:59], v[58:59] op_sel_hi:[1,0,0]
  v_pk_fma_f32 v[134:135], v[134:135], v[58:59], v[58:59] op_sel_hi:[1,0,0]
  v_rcp_f32 v128, v128
  v_rcp_f32 v129, v129
  buffer_load_dwordx4 v75, s[36:39], s93 offen offset:1024 lds
  v_rcp_f32 v130, v130
  v_rcp_f32 v131, v131
  v_rcp_f32 v132, v132
  v_rcp_f32 v133, v133
  v_rcp_f32 v134, v134
  v_rcp_f32 v135, v135
  v_pk_mul_f32 v[192:193], v[192:193], v[128:129]
  v_pk_mul_f32 v[194:195], v[194:195], v[130:131]
  v_pk_mul_f32 v[196:197], v[196:197], v[132:133]
  v_pk_mul_f32 v[198:199], v[198:199], v[134:135]
  s_cmp_lg_u32 s3, 0
  s_cbranch_scc1 L_pw_22
  s_load_dwordx2 s[20:21], s[64:65], 128 glc
L_pw_22:
  v_cvt_pk_bf16_f32 v200, v192, v193
  v_cvt_pk_bf16_f32 v201, v194, v195
  v_cvt_pk_bf16_f32 v202, v196, v197
  buffer_load_dwordx4 v76, s[36:39], s93 offen offset:2048 lds
  v_cvt_pk_bf16_f32 v203, v198, v199
  buffer_store_dwordx4 v[200:203], v50, s[12:15], s96 offen offset:0 sc1
  v_pk_mul_f32 v[128:129], v[208:209], v[208:209]
  v_pk_mul_f32 v[130:131], v[210:211], v[210:211]
  v_pk_mul_f32 v[132:133], v[212:213], v[212:213]
  v_pk_mul_f32 v[134:135], v[214:215], v[214:215]
  v_pk_fma_f32 v[128:129], v[128:129], v[56:57], v[54:55] op_sel:[0,1,1]
  v_pk_fma_f32 v[130:131], v[130:131], v[56:57], v[54:55] op_sel:[0,1,1]
  v_pk_fma_f32 v[132:133], v[132:133], v[56:57], v[54:55] op_sel:[0,1,1]
  v_pk_fma_f32 v[134:135], v[134:135], v[56:57], v[54:55] op_sel:[0,1,1]
  v_pk_mul_f32 v[128:129], v[128:129], v[208:209]
  v_pk_mul_f32 v[130:131], v[130:131], v[210:211]
  v_pk_mul_f32 v[132:133], v[132:133], v[212:213]
  v_pk_mul_f32 v[134:135], v[134:135], v[214:215]
  v_exp_f32 v128, v128
  v_exp_f32 v129, v129
  buffer_load_dwordx4 v77, s[36:39], s93 offen offset:3072 lds
  v_exp_f32 v130, v130
  v_exp_f32 v131, v131
  v_exp_f32 v132, v132
  v_exp_f32 v133, v133
  v_exp_f32 v134, v134
  v_exp_f32 v135, v135
  v_pk_mul_f32 v[208:209], v[208:209], v[216:217]
  v_pk_mul_f32 v[210:211], v[210:211], v[218:219]
  v_pk_mul_f32 v[212:213], v[212:213], v[220:221]
  v_pk_mul_f32 v[214:215], v[214:215], v[222:223]
  v_pk_fma_f32 v[128:129], v[128:129], v[58:59], v[58:59] op_sel:[0,1,1]
  v_pk_fma_f32 v[130:131], v[130:131], v[58:59], v[58:59] op_sel:[0,1,1]
  v_pk_fma_f32 v[132:133], v[132:133], v[58:59], v[58:59] op_sel:[0,1,1]
  v_pk_fma_f32 v[134:135], v[134:135], v[58:59], v[58:59] op_sel:[0,1,1]
  s_add_u32 m0, s56, 32768
  s_add_u32 s93, s100, 86016
  buffer_load_dwordx4 v74, s[36:39], s93 offen offset:0 lds
  v_rcp_f32 v128, v128
  v_rcp_f32 v129, v129
  v_rcp_f32 v130, v130
  v_rcp_f32 v131, v131
  v_rcp_f32 v132, v132
  v_rcp_f32 v133, v133
  v_rcp_f32 v134, v134
  v_rcp_f32 v135, v135
  v_pk_mul_f32 v[208:209], v[208:209], v[128:129]
  v_pk_mul_f32 v[210:211], v[210:211], v[130:131]
  v_pk_mul_f32 v[212:213], v[212:213], v[132:133]
  v_pk_mul_f32 v[214:215], v[214:215], v[134:135]
  buffer_load_dwordx4 v75, s[36:39], s93 offen offset:1024 lds
  v_cvt_pk_bf16_f32 v216, v208, v209
  v_cvt_pk_bf16_f32 v217, v210, v211
  v_cvt_pk_bf16_f32 v218, v212, v213
  v_cvt_pk_bf16_f32 v219, v214, v215
  buffer_store_dwordx4 v[216:219], v50, s[12:15], s97 offen offset:0 sc1
  s_waitcnt vmcnt(12)
  buffer_store_byte v79, v94, s[12:15], 0 offen sc1
  v_pk_mul_f32 v[128:129], v[224:225], v[224:225]
  v_pk_mul_f32 v[130:131], v[226:227], v[226:227]
  v_pk_mul_f32 v[132:133], v[228:229], v[228:229]
  v_pk_mul_f32 v[134:135], v[230:231], v[230:231]
  v_pk_fma_f32 v[128:129], v[128:129], v[56:57], v[54:55] op_sel_hi:[1,0,0]
  v_pk_fma_f32 v[130:131], v[130:131], v[56:57], v[54:55] op_sel_hi:[1,0,0]
  v_pk_fma_f32 v[132:133], v[132:133], v[56:57], v[54:55] op_sel_hi:[1,0,0]
  v_pk_fma_f32 v[134:135], v[134:135], v[56:57], v[54:55] op_sel_hi:[1,0,0]
  v_pk_mul_f32 v[128:129], v[128:129], v[224:225]
  buffer_load_dwordx4 v76, s[36:39], s93 offen offset:2048 lds
  v_pk_mul_f32 v[130:131], v[130:131], v[226:227]
  v_pk_mul_f32 v[132:133], v[132:133], v[228:229]
  v_pk_mul_f32 v[134:135], v[134:135], v[230:231]
  v_exp_f32 v128, v128
  v_exp_f32 v129, v129
  v_exp_f32 v130, v130
  v_exp_f32 v131, v131
  v_exp_f32 v132, v132
  v_exp_f32 v133, v133
  v_exp_f32 v134, v134
  v_exp_f32_e64 v135, v135
  v_pk_mul_f32 v[224:225], v[224:225], v[232:233]
  buffer_load_dwordx4 v77, s[36:39], s93 offen offset:3072 lds
  v_pk_mul_f32 v[226:227], v[226:227], v[234:235]
  v_pk_mul_f32 v[228:229], v[228:229], v[236:237]
  v_pk_mul_f32 v[230:231], v[230:231], v[238:239]
  v_pk_fma_f32 v[128:129], v[128:129], v[58:59], v[58:59] op_sel_hi:[1,0,0]
  v_pk_fma_f32 v[130:131], v[130:131], v[58:59], v[58:59] op_sel_hi:[1,0,0]
  v_pk_fma_f32 v[132:133], v[132:133], v[58:59], v[58:59] op_sel_hi:[1,0,0]
  v_pk_fma_f32 v[134:135], v[134:135], v[58:59], v[58:59] op_sel_hi:[1,0,0]
  v_rcp_f32 v128, v128
  v_rcp_f32 v129, v129
  v_rcp_f32 v130, v130
  v_rcp_f32 v131, v131
  v_rcp_f32 v132, v132
  v_rcp_f32 v133, v133
  v_rcp_f32_e64 v134, v134
  s_waitcnt lgkmcnt(15)
  s_add_u32 m0, s56, 0
  s_add_u32 s93, s100, 172032
  buffer_load_dwordx4 v74, s[36:39], s93 offen offset:0 lds
  v_rcp_f32_e64 v135, v135
  v_pk_mul_f32 v[224:225], v[224:225], v[128:129]
  v_pk_mul_f32 v[226:227], v[226:227], v[130:131]
  v_pk_mul_f32 v[228:229], v[228:229], v[132:133]
  v_pk_mul_f32 v[230:231], v[230:231], v[134:135]
  v_cvt_pk_bf16_f32 v232, v224, v225
  v_cvt_pk_bf16_f32 v233, v226, v227
  v_cvt_pk_bf16_f32 v234, v228, v229
  v_cvt_pk_bf16_f32 v235, v230, v231
  buffer_store_dwordx4 v[232:235], v50, s[12:15], s96 offen offset:1024 sc1
  v_pk_mul_f32 v[128:129], v[240:241], v[240:241]
  v_pk_mul_f32 v[130:131], v[242:243], v[242:243]
  v_pk_mul_f32 v[132:133], v[244:245], v[244:245]
  v_pk_mul_f32 v[134:135], v[246:247], v[246:247]
  v_pk_fma_f32 v[128:129], v[128:129], v[56:57], v[54:55] op_sel:[0,1,1]
  v_pk_fma_f32 v[130:131], v[130:131], v[56:57], v[54:55] op_sel:[0,1,1]
  v_pk_fma_f32 v[132:133], v[132:133], v[56:57], v[54:55] op_sel:[0,1,1]
  buffer_load_dwordx4 v75, s[36:39], s93 offen offset:1024 lds
  v_pk_fma_f32 v[134:135], v[134:135], v[56:57], v[54:55] op_sel:[0,1,1]
  v_pk_mul_f32 v[128:129], v[128:129], v[240:241]
  v_pk_mul_f32 v[130:131], v[130:131], v[242:243]
  v_pk_mul_f32 v[132:133], v[132:133], v[244:245]
  v_pk_mul_f32 v[134:135], v[134:135], v[246:247]
  v_exp_f32 v128, v128
  v_exp_f32 v129, v129
  v_exp_f32 v130, v130
  v_exp_f32 v131, v131
  v_exp_f32 v132, v132
  v_exp_f32 v133, v133
  v_exp_f32 v134, v134
  v_exp_f32 v135, v135
  buffer_load_dwordx4 v76, s[36:39], s93 offen offset:2048 lds
  v_pk_mul_f32 v[240:241], v[240:241], v[248:249]
  v_pk_mul_f32 v[242:243], v[242:243], v[250:251]
  v_pk_mul_f32 v[244:245], v[244:245], v[252:253]
  v_pk_mul_f32 v[246:247], v[246:247], v[254:255]
  v_pk_fma_f32 v[128:129], v[128:129], v[58:59], v[58:59] op_sel:[0,1,1]
  v_pk_fma_f32 v[130:131], v[130:131], v[58:59], v[58:59] op_sel:[0,1,1]
  v_pk_fma_f32 v[132:133], v[132:133], v[58:59], v[58:59] op_sel:[0,1,1]
  v_pk_fma_f32 v[134:135], v[134:135], v[58:59], v[58:59] op_sel:[0,1,1]
  v_rcp_f32 v128, v128
  v_rcp_f32 v129, v129
  v_rcp_f32 v130, v130
  v_rcp_f32 v131, v131
  v_rcp_f32 v132, v132
  v_rcp_f32 v133, v133
  buffer_load_dwordx4 v77, s[36:39], s93 offen offset:3072 lds
  v_rcp_f32 v134, v134
  v_rcp_f32 v135, v135
  v_pk_mul_f32 v[240:241], v[240:241], v[128:129]
  v_pk_mul_f32 v[242:243], v[242:243], v[130:131]
  v_pk_mul_f32 v[244:245], v[244:245], v[132:133]
  v_pk_mul_f32 v[246:247], v[246:247], v[134:135]
  v_cvt_pk_bf16_f32 v248, v240, v241
  v_cvt_pk_bf16_f32 v249, v242, v243
  v_cvt_pk_bf16_f32 v250, v244, v245
  v_cvt_pk_bf16_f32 v251, v246, v247
  buffer_store_dwordx4 v[248:251], v50, s[12:15], s97 offen offset:1024 sc1
  s_waitcnt vmcnt(17)
  ds_read_b64_tr_b16 a[64:65], v46 offset:16384
  ds_read_b64_tr_b16 a[66:67], v46 offset:17408
  ds_read_b64_tr_b16 a[68:69], v47 offset:16384
  ds_read_b64_tr_b16 a[70:71], v47 offset:17408
  ds_read_b64_tr_b16 a[72:73], v46 offset:18432
  ds_read_b64_tr_b16 a[74:75], v46 offset:19456
  ds_read_b64_tr_b16 a[76:77], v47 offset:18432
  ds_read_b64_tr_b16 a[78:79], v47 offset:19456
  s_waitcnt lgkmcnt(15)
  s_add_u32 m0, s56, 16384
  s_add_u32 s93, s100, 200704
  buffer_load_dwordx4 v74, s[36:39], s93 offen offset:0 lds
  s_waitcnt vmcnt(13)
  ds_read_b64_tr_b16 a[80:81], v46 offset:0
  ds_read_b64_tr_b16 a[82:83], v46 offset:1024
  ds_read_b64_tr_b16 a[84:85], v47 offset:0
  ds_read_b64_tr_b16 a[86:87], v47 offset:1024
  ds_read_b64_tr_b16 a[88:89], v46 offset:2048
  ds_read_b64_tr_b16 a[90:91], v46 offset:3072
  ds_read_b64_tr_b16 a[92:93], v47 offset:2048
  ds_read_b64_tr_b16 a[94:95], v47 offset:3072
  buffer_load_dwordx4 v75, s[36:39], s93 offen offset:1024 lds
  v_cmp_eq_u32 vcc, 1, v51
  v_mov_b32 v67, 0x3f80
  v_mov_b32 v66, 0
  v_cndmask_b32 v8, v8, v67, vcc
  v_cndmask_b32_e64 v9, v9, v66, vcc
  buffer_load_dwordx4 v76, s[36:39], s93 offen offset:2048 lds
  buffer_load_dwordx4 v77, s[36:39], s93 offen offset:3072 lds
  s_cmp_lg_u32 s3, 0
  s_cbranch_scc1 L_pw_23
  s_waitcnt lgkmcnt(0)
  s_andn2_b32 s20, s69, s20
  s_andn2_b32 s21, s73, s21
  s_or_b32 s20, s20, s21
  s_cmp_eq_u32 s20, 0
  s_cbranch_scc1 L_ok_20
  s_mov_b32 s94, 0
L_spin_21:
  s_sleep 4
  s_load_dwordx2 s[20:21], s[64:65], 128 glc
  s_add_u32 s94, s94, 1
  s_cmp_gt_u32 s94, 3145728
  s_cbranch_scc1 L_ok_20
  s_waitcnt lgkmcnt(0)
  s_andn2_b32 s20, s69, s20
  s_andn2_b32 s21, s73, s21
  s_or_b32 s20, s20, s21
  s_cmp_eq_u32 s20, 0
  s_cbranch_scc0 L_spin_21
L_ok_20:
L_pw_23:
  s_barrier
  s_add_u32 m0, s76, 139264
  s_add_u32 s77, s74, 3790848
  buffer_load_dwordx4 v10, s[12:15], s77 offen offset:0 sc1 lds
  buffer_load_dwordx4 v11, s[12:15], s77 offen offset:1024 sc1 lds
  ds_read_b64 a[224:225], v42 offset:0
  ds_read_b64 a[226:227], v42 offset:3072
  ds_read_b64 a[228:229], v42 offset:12288
  ds_read_b64 a[230:231], v42 offset:15360
  ds_read_b64 a[232:233], v42 offset:256
  ds_read_b64 a[234:235], v42 offset:3328
  ds_read_b64 a[236:237], v42 offset:12544
  ds_read_b64 a[238:239], v42 offset:15616
  s_waitcnt lgkmcnt(4)
  v_mfma_f32_32x32x16_bf16 v[96:111], a[224:227], v[2:5], v[96:111]
  ds_read_b64 a[240:241], v42 offset:512
  ds_read_b64 a[242:243], v42 offset:3584
  ds_read_b64 a[244:245], v42 offset:12800
  ds_read_b64 a[246:247], v42 offset:15872
  v_mfma_f32_32x32x16_bf16 v[96:111], a[228:231], v[6:9], v[96:111]
  buffer_load_dwordx4 v12, s[12:15], s77 offen offset:2048 sc1 lds
  s_waitcnt lgkmcnt(4)
  v_mfma_f32_32x32x16_bf16 v[128:143], a[232:235], v[2:5], 0
  ds_read_b64 a[224:225], v42 offset:768
  ds_read_b64 a[226:227], v42 offset:3840
  ds_read_b64 a[228:229], v42 offset:13056
  ds_read_b64 a[230:231], v42 offset:16128
  v_mfma_f32_32x32x16_bf16 v[128:143], a[236:239], v[6:9], v[128:143]
  s_cmp_eq_u32 s3, 3
  s_cbranch_scc1 L_w3_24
  s_add_u32 m0, s76, 151680
  s_add_u32 s77, s74, 3857408
  buffer_load_dwordx4 v10, s[12:15], s77 offen offset:0 sc1 lds
  buffer_load_dwordx4 v11, s[12:15], s77 offen offset:1024 sc1 lds
  buffer_load_dwordx4 v12, s[12:15], s77 offen offset:2048 sc1 lds
L_w3_24:
  s_waitcnt lgkmcnt(4)
  v_mfma_f32_32x32x16_bf16 v[144:159], a[240:243], v[2:5], 0
  ds_read_b64 a[232:233], v42 offset:1024
  ds_read_b64 a[234:235], v42 offset:4096
  ds_read_b64 a[236:237], v42 offset:13312
  ds_read_b64 a[238:239], v42 offset:16384
  v_max_f32 v54, v96, v97
  v_max_f32 v55, v98, v99
  v_mfma_f32_32x32x16_bf16 v[144:159], a[244:247], v[6:9], v[144:159]
  v_max3_f32 v54, v54, v100, v101
  v_max3_f32 v55, v55, v102, v103
  v_max3_f32 v54, v54, v104, v105
  v_max3_f32 v55, v55, v106, v107
  v_max3_f32 v54, v54, v108, v109
  v_max3_f32 v55, v55, v110, v111
  s_add_u32 m0, s56, 98304
  s_add_u32 s93, s100, 57344
  buffer_load_dwordx4 v74, s[36:39], s93 offen offset:0 lds
  s_waitcnt lgkmcnt(4)
  v_mfma_f32_32x32x16_bf16 v[160:175], a[224:227], v[2:5], 0
  ds_read_b64 a[240:241], v42 offset:1280
  ds_read_b64 a[242:243], v42 offset:4352
  ds_read_b64 a[244:245], v42 offset:13568
  ds_read_b64 a[246:247], v42 offset:16640
  v_max3_f32 v54, v54, v128, v129
  v_max3_f32 v55, v55, v130, v131
  v_mfma_f32_32x32x16_bf16 v[160:175], a[228:231], v[6:9], v[160:175]
  v_max3_f32 v54, v54, v132, v133
  v_max3_f32 v55, v55, v134, v135
  v_max3_f32 v54, v54, v136, v137
  v_max3_f32 v55, v55, v138, v139
  v_max3_f32 v54, v54, v140, v141
  v_max3_f32 v55, v55, v142, v143
  buffer_load_dwordx4 v75, s[36:39], s93 offen offset:1024 lds
  s_waitcnt lgkmcnt(4)
  v_mfma_f32_32x32x16_bf16 v[176:191], a[232:235], v[2:5], 0
  ds_read_b64 a[224:225], v42 offset:1536
  ds_read_b64 a[226:227], v42 offset:4608
  ds_read_b64 a[228:229], v42 offset:13824
  ds_read_b64 a[230:231], v42 offset:16896
  v_max3_f32 v54, v54, v144, v145
  v_max3_f32 v55, v55, v146, v147
  v_mfma_f32_32x32x16_bf16 v[176:191], a[236:239], v[6:9], v[176:191]
  v_max3_f32 v54, v54, v148, v149
  v_max3_f32 v55, v55, v150, v151
  v_max3_f32 v54, v54, v152, v153
  v_max3_f32 v55, v55, v154, v155
  v_max3_f32 v54, v54, v156, v157
  v_max3_f32 v55, v55, v158, v159
  buffer_load_dwordx4 v76, s[36:39], s93 offen offset:2048 lds
  s_waitcnt lgkmcnt(4)
  v_mfma_f32_32x32x16_bf16 v[192:207], a[240:243], v[2:5], 0
  ds_read_b64 a[232:233], v42 offset:1792
  ds_read_b64 a[234:235], v42 offset:4864
  ds_read_b64 a[236:237], v42 offset:14080
  ds_read_b64 a[238:239], v42 offset:17152
  v_max3_f32 v54, v54, v160, v161
  v_max3_f32 v55, v55, v162, v163
  v_mfma_f32_32x32x16_bf16 v[192:207], a[244:247], v[6:9], v[192:207]
  v_max3_f32 v54, v54, v164, v165
  v_max3_f32 v55, v55, v166, v167
  v_max3_f32 v54, v54, v168, v169
  v_max3_f32 v55, v55, v170, v171
  v_max3_f32 v54, v54, v172, v173
  v_max3_f32 v55, v55, v174, v175
  buffer_load_dwordx4 v77, s[36:39], s93 offen offset:3072 lds
  s_waitcnt lgkmcnt(4)
  v_mfma_f32_32x32x16_bf16 v[208:223], a[224:227], v[2:5], 0
  ds_read_b64 a[240:241], v42 offset:2048
  ds_read_b64 a[242:243], v42 offset:5120
  ds_read_b64 a[244:245], v42 offset:14336
  ds_read_b64 a[246:247], v42 offset:17408
  v_max3_f32 v54, v54, v176, v177
  v_max3_f32 v55, v55, v178, v179
  v_mfma_f32_32x32x16_bf16 v[208:223], a[228:231], v[6:9], v[208:223]
  v_max3_f32 v54, v54, v180, v181
  v_max3_f32 v55, v55, v182, v183
  v_max3_f32 v54, v54, v184, v185
  v_max3_f32 v55, v55, v186, v187
  v_max3_f32 v54, v54, v188, v189
  v_max3_f32 v55, v55, v190, v191
  s_add_u32 m0, s56, 49152
  s_add_u32 s93, s100, 286720
  buffer_load_dwordx4 v74, s[36:39], s93 offen offset:0 lds
  s_waitcnt lgkmcnt(4)
  v_mfma_f32_32x32x16_bf16 v[224:239], a[232:235], v[2:5], 0
  v_max3_f32 v54, v54, v192, v193
  v_max3_f32 v55, v55, v194, v195
  v_mfma_f32_32x32x16_bf16 v[224:239], a[236:239], v[6:9], v[224:239]
  v_max3_f32 v54, v54, v196, v197
  v_max3_f32 v55, v55, v198, v199
  v_max3_f32 v54, v54, v200, v201
  v_max3_f32 v55, v55, v202, v203
  v_max3_f32 v54, v54, v204, v205
  v_max3_f32 v55, v55, v206, v207
  buffer_load_dwordx4 v75, s[36:39], s93 offen offset:1024 lds
  s_waitcnt lgkmcnt(0)
  v_mfma_f32_32x32x16_bf16 v[112:127], a[240:243], v[2:5], v[112:127]
  v_max3_f32 v54, v54, v208, v209
  v_max3_f32 v55, v55, v210, v211
  v_mfma_f32_32x32x16_bf16 v[112:127], a[244:247], v[6:9], v[112:127]
  v_max3_f32 v54, v54, v212, v213
  v_max3_f32 v55, v55, v214, v215
  v_max3_f32 v54, v54, v216, v217
  v_max3_f32 v55, v55, v218, v219
  v_max3_f32 v54, v54, v220, v221
  v_max3_f32 v55, v55, v222, v223
  buffer_load_dwordx4 v76, s[36:39], s93 offen offset:2048 lds
  v_max3_f32 v54, v54, v224, v225
  v_max3_f32 v55, v55, v226, v227
  v_max3_f32 v54, v54, v228, v229
  v_max3_f32 v55, v55, v230, v231
  v_max3_f32 v54, v54, v232, v233
  v_max3_f32 v55, v55, v234, v235
  v_max3_f32 v54, v54, v236, v237
  v_max3_f32 v55, v55, v238, v239
  s_lshl1_add_u32 s57, s70, s6
  s_mul_i32 s57, s57, 114688
  s_add_u32 s57, s57, 8388608
  s_mul_i32 s96, s3, 24576
  s_add_u32 s96, s96, s57
  s_mul_i32 s78, s6, -229376
  s_add_u32 s78, s78, 114688
  v_max3_f32 v54, v54, v112, v113
  v_max3_f32 v55, v55, v114, v115
  v_max3_f32 v54, v54, v116, v117
  v_max3_f32 v55, v55, v118, v119
  v_max3_f32 v54, v54, v120, v121
  v_max3_f32 v55, v55, v122, v123
  v_max3_f32 v54, v54, v124, v125
  v_max3_f32 v55, v55, v126, v127
  v_max_f32 v54, v54, v55
  v_mov_b32 v55, v54
  v_mov_b32 v56, 0x3e8b97f6
  s_nop 0
  v_permlane32_swap_b32 v54, v55
  v_max_f32_e64 v54, v54, v55
  v_mul_f32 v58, 0xbe8b97f6, v54
  v_pk_fma_f32 v[96:97], v[96:97], v[56:57], v[58:59] op_sel_hi:[1,0,0]
  v_pk_fma_f32 v[98:99], v[98:99], v[56:57], v[58:59] op_sel_hi:[1,0,0]
  v_pk_fma_f32 v[100:101], v[100:101], v[56:57], v[58:59] op_sel_hi:[1,0,0]
  v_pk_fma_f32 v[102:103], v[102:103], v[56:57], v[58:59] op_sel_hi:[1,0,0]
  v_pk_fma_f32 v[104:105], v[104:105], v[56:57], v[58:59] op_sel_hi:[1,0,0]
  v_pk_fma_f32 v[106:107], v[106:107], v[56:57], v[58:59] op_sel_hi:[1,0,0]
  v_pk_fma_f32 v[108:109], v[108:109], v[56:57], v[58:59] op_sel_hi:[1,0,0]
  v_pk_fma_f32 v[110:111], v[110:111], v[56:57], v[58:59] op_sel_hi:[1,0,0]
  v_pk_fma_f32 v[128:129], v[128:129], v[56:57], v[58:59] op_sel_hi:[1,0,0]
  v_pk_fma_f32 v[130:131], v[130:131], v[56:57], v[58:59] op_sel_hi:[1,0,0]
  v_pk_fma_f32 v[132:133], v[132:133], v[56:57], v[58:59] op_sel_hi:[1,0,0]
  v_pk_fma_f32 v[134:135], v[134:135], v[56:57], v[58:59] op_sel_hi:[1,0,0]
  v_pk_fma_f32 v[136:137], v[136:137], v[56:57], v[58:59] op_sel_hi:[1,0,0]
  v_pk_fma_f32 v[138:139], v[138:139], v[56:57], v[58:59] op_sel_hi:[1,0,0]
  v_pk_fma_f32 v[140:141], v[140:141], v[56:57], v[58:59] op_sel_hi:[1,0,0]
  v_pk_fma_f32 v[142:143], v[142:143], v[56:57], v[58:59] op_sel_hi:[1,0,0]
  buffer_load_dwordx4 v77, s[36:39], s93 offen offset:3072 lds
  v_pk_fma_f32 v[144:145], v[144:145], v[56:57], v[58:59] op_sel_hi:[1,0,0]
  v_pk_fma_f32 v[146:147], v[146:147], v[56:57], v[58:59] op_sel_hi:[1,0,0]
  v_pk_fma_f32 v[148:149], v[148:149], v[56:57], v[58:59] op_sel_hi:[1,0,0]
  v_pk_fma_f32 v[150:151], v[150:151], v[56:57], v[58:59] op_sel_hi:[1,0,0]
  v_pk_fma_f32 v[152:153], v[152:153], v[56:57], v[58:59] op_sel_hi:[1,0,0]
  v_pk_fma_f32 v[154:155], v[154:155], v[56:57], v[58:59] op_sel_hi:[1,0,0]
  v_pk_fma_f32 v[156:157], v[156:157], v[56:57], v[58:59] op_sel_hi:[1,0,0]
  v_pk_fma_f32 v[158:159], v[158:159], v[56:57], v[58:59] op_sel_hi:[1,0,0]
  v_pk_fma_f32 v[160:161], v[160:161], v[56:57], v[58:59] op_sel_hi:[1,0,0]
  v_pk_fma_f32 v[162:163], v[162:163], v[56:57], v[58:59] op_sel_hi:[1,0,0]
  v_pk_fma_f32 v[164:165], v[164:165], v[56:57], v[58:59] op_sel_hi:[1,0,0]
  v_pk_fma_f32 v[166:167], v[166:167], v[56:57], v[58:59] op_sel_hi:[1,0,0]
  v_pk_fma_f32 v[168:169], v[168:169], v[56:57], v[58:59] op_sel_hi:[1,0,0]
  v_pk_fma_f32 v[170:171], v[170:171], v[56:57], v[58:59] op_sel_hi:[1,0,0]
  v_pk_fma_f32 v[172:173], v[172:173], v[56:57], v[58:59] op_sel_hi:[1,0,0]
  v_pk_fma_f32 v[174:175], v[174:175], v[56:57], v[58:59] op_sel_hi:[1,0,0]
  s_add_u32 m0, s56, 81920
  s_add_u32 s93, s100, 315392
  buffer_load_dwordx4 v74, s[36:39], s93 offen offset:0 lds
  v_pk_fma_f32 v[176:177], v[176:177], v[56:57], v[58:59] op_sel_hi:[1,0,0]
  v_pk_fma_f32 v[178:179], v[178:179], v[56:57], v[58:59] op_sel_hi:[1,0,0]
  v_pk_fma_f32 v[180:181], v[180:181], v[56:57], v[58:59] op_sel_hi:[1,0,0]
  v_pk_fma_f32 v[182:183], v[182:183], v[56:57], v[58:59] op_sel_hi:[1,0,0]
  v_pk_fma_f32 v[184:185], v[184:185], v[56:57], v[58:59] op_sel_hi:[1,0,0]
  v_pk_fma_f32 v[186:187], v[186:187], v[56:57], v[58:59] op_sel_hi:[1,0,0]
  v_pk_fma_f32 v[188:189], v[188:189], v[56:57], v[58:59] op_sel_hi:[1,0,0]
  v_pk_fma_f32 v[190:191], v[190:191], v[56:57], v[58:59] op_sel_hi:[1,0,0]
  v_pk_fma_f32 v[192:193], v[192:193], v[56:57], v[58:59] op_sel_hi:[1,0,0]
  v_pk_fma_f32 v[194:195], v[194:195], v[56:57], v[58:59] op_sel_hi:[1,0,0]
  v_pk_fma_f32 v[196:197], v[196:197], v[56:57], v[58:59] op_sel_hi:[1,0,0]
  v_pk_fma_f32 v[198:199], v[198:199], v[56:57], v[58:59] op_sel_hi:[1,0,0]
  v_pk_fma_f32 v[200:201], v[200:201], v[56:57], v[58:59] op_sel_hi:[1,0,0]
  v_pk_fma_f32 v[202:203], v[202:203], v[56:57], v[58:59] op_sel_hi:[1,0,0]
  v_pk_fma_f32 v[204:205], v[204:205], v[56:57], v[58:59] op_sel_hi:[1,0,0]
  v_pk_fma_f32 v[206:207], v[206:207], v[56:57], v[58:59] op_sel_hi:[1,0,0]
  buffer_load_dwordx4 v75, s[36:39], s93 offen offset:1024 lds
  v_pk_fma_f32 v[208:209], v[208:209], v[56:57], v[58:59] op_sel_hi:[1,0,0]
  v_pk_fma_f32 v[210:211], v[210:211], v[56:57], v[58:59] op_sel_hi:[1,0,0]
  v_pk_fma_f32 v[212:213], v[212:213], v[56:57], v[58:59] op_sel_hi:[1,0,0]
  v_pk_fma_f32 v[214:215], v[214:215], v[56:57], v[58:59] op_sel_hi:[1,0,0]
  v_pk_fma_f32 v[216:217], v[216:217], v[56:57], v[58:59] op_sel_hi:[1,0,0]
  v_pk_fma_f32 v[218:219], v[218:219], v[56:57], v[58:59] op_sel_hi:[1,0,0]
  v_pk_fma_f32 v[220:221], v[220:221], v[56:57], v[58:59] op_sel_hi:[1,0,0]
  v_pk_fma_f32 v[222:223], v[222:223], v[56:57], v[58:59] op_sel_hi:[1,0,0]
  v_pk_fma_f32 v[224:225], v[224:225], v[56:57], v[58:59] op_sel_hi:[1,0,0]
  v_pk_fma_f32 v[226:227], v[226:227], v[56:57], v[58:59] op_sel_hi:[1,0,0]
  v_pk_fma_f32 v[228:229], v[228:229], v[56:57], v[58:59] op_sel_hi:[1,0,0]
  v_pk_fma_f32 v[230:231], v[230:231], v[56:57], v[58:59] op_sel_hi:[1,0,0]
  v_pk_fma_f32 v[232:233], v[232:233], v[56:57], v[58:59] op_sel_hi:[1,0,0]
  v_pk_fma_f32 v[234:235], v[234:235], v[56:57], v[58:59] op_sel_hi:[1,0,0]
  v_pk_fma_f32 v[236:237], v[236:237], v[56:57], v[58:59] op_sel_hi:[1,0,0]
  v_pk_fma_f32 v[238:239], v[238:239], v[56:57], v[58:59] op_sel_hi:[1,0,0]
  buffer_load_dwordx4 v76, s[36:39], s93 offen offset:2048 lds
  v_pk_fma_f32 v[112:113], v[112:113], v[56:57], v[58:59] op_sel_hi:[1,0,0]
  v_pk_fma_f32 v[114:115], v[114:115], v[56:57], v[58:59] op_sel_hi:[1,0,0]
  v_pk_fma_f32 v[116:117], v[116:117], v[56:57], v[58:59] op_sel_hi:[1,0,0]
  v_pk_fma_f32 v[118:119], v[118:119], v[56:57], v[58:59] op_sel_hi:[1,0,0]
  v_pk_fma_f32 v[120:121], v[120:121], v[56:57], v[58:59] op_sel_hi:[1,0,0]
  v_pk_fma_f32 v[122:123], v[122:123], v[56:57], v[58:59] op_sel_hi:[1,0,0]
  v_pk_fma_f32 v[124:125], v[124:125], v[56:57], v[58:59] op_sel_hi:[1,0,0]
  v_pk_fma_f32 v[126:127], v[126:127], v[56:57], v[58:59] op_sel_hi:[1,0,0]
  s_waitcnt vmcnt(11)
  s_barrier
  ds_read_b64_tr_b16 a[224:225], v43 offset:0
  ds_read_b64_tr_b16 a[226:227], v43 offset:64
  ds_read_b64_tr_b16 a[228:229], v43 offset:128
  ds_read_b64_tr_b16 a[230:231], v43 offset:192
  ds_read_b64_tr_b16 a[232:233], v43 offset:256
  ds_read_b64_tr_b16 a[234:235], v43 offset:320
  ds_read_b64_tr_b16 a[236:237], v43 offset:384
  ds_read_b64_tr_b16 a[238:239], v43 offset:448
  s_add_u32 s97, s56, s57
  s_add_u32 s97, s97, 98304
  v_exp_f32 v96, v96
  v_exp_f32 v97, v97
  v_exp_f32 v98, v98
  v_exp_f32_e64 v99, v99
  buffer_load_dwordx4 v77, s[36:39], s93 offen offset:3072 lds
  v_exp_f32 v100, v100
  v_exp_f32 v101, v101
  v_exp_f32 v102, v102
  v_exp_f32 v103, v103
  s_add_u32 m0, s56, 65536
  s_add_u32 s93, s101, 0
  buffer_load_dwordx4 v74, s[36:39], s93 offen offset:0 lds
  v_cvt_pk_bf16_f32 v96, v96, v97
  v_cvt_pk_bf16_f32 v97, v98, v99
  v_cvt_pk_bf16_f32 v98, v100, v101
  v_cvt_pk_bf16_f32 v99, v102, v103
  v_exp_f32 v104, v104
  v_exp_f32 v105, v105
  s_waitcnt lgkmcnt(4)
  v_mfma_f32_32x32x16_bf16 v[18:33], a[224:227], v[96:99], 0
  v_exp_f32 v106, v106
  v_exp_f32 v107, v107
  buffer_load_dwordx4 v75, s[36:39], s93 offen offset:1024 lds
  v_exp_f32 v108, v108
  v_exp_f32 v109, v109
  v_exp_f32 v110, v110
  v_exp_f32 v111, v111
  buffer_load_dwordx4 v76, s[36:39], s93 offen offset:2048 lds
  v_cvt_pk_bf16_f32 v100, v104, v105
  v_cvt_pk_bf16_f32 v101, v106, v107
  v_cvt_pk_bf16_f32 v102, v108, v109
  v_cvt_pk_bf16_f32 v103, v110, v111
  ds_read_b64_tr_b16 a[240:241], v43 offset:512
  ds_read_b64_tr_b16 a[242:243], v43 offset:576
  ds_read_b64_tr_b16 a[244:245], v43 offset:640
  ds_read_b64_tr_b16 a[246:247], v43 offset:704
  buffer_store_byte v69, v94, s[12:15], 0 offen sc1
  s_load_dwordx2 s[16:17], s[66:67], 0 glc
  v_exp_f32 v128, v128
  v_exp_f32 v129, v129
  v_mfma_f32_32x32x16_bf16 v[18:33], a[228:231], v[100:103], v[18:33]
  v_exp_f32 v130, v130
  v_exp_f32 v131, v131
  buffer_load_dwordx4 v77, s[36:39], s93 offen offset:3072 lds
  v_exp_f32 v132, v132
  v_exp_f32 v133, v133
  v_exp_f32 v134, v134
  v_exp_f32 v135, v135
  v_cvt_pk_bf16_f32 v128, v128, v129
  v_cvt_pk_bf16_f32 v129, v130, v131
  v_cvt_pk_bf16_f32 v130, v132, v133
  v_cvt_pk_bf16_f32 v131, v134, v135
  v_exp_f32 v136, v136
  v_exp_f32_e64 v137, v137
  s_waitcnt lgkmcnt(4)
  v_mfma_f32_32x32x16_bf16 v[18:33], a[232:235], v[128:131], v[18:33]
  v_exp_f32 v138, v138
  v_exp_f32 v139, v139
  v_exp_f32 v140, v140
  v_exp_f32 v141, v141
  v_exp_f32 v142, v142
  v_exp_f32 v143, v143
  v_cvt_pk_bf16_f32 v132, v136, v137
  v_cvt_pk_bf16_f32 v133, v138, v139
  v_cvt_pk_bf16_f32 v134, v140, v141
  v_cvt_pk_bf16_f32 v135, v142, v143
  ds_read_b64_tr_b16 a[224:225], v43 offset:768
  ds_read_b64_tr_b16 a[226:227], v43 offset:832
  ds_read_b64_tr_b16 a[228:229], v43 offset:896
  ds_read_b64_tr_b16 a[230:231], v43 offset:960
  s_waitcnt vmcnt(13)
  ds_read_b64_tr_b16 a[96:97], v46 offset:32768
  ds_read_b64_tr_b16 a[98:99], v46 offset:33792
  ds_read_b64_tr_b16 a[100:101], v47 offset:32768
  ds_read_b64_tr_b16 a[102:103], v47 offset:33792
  ds_read_b64_tr_b16 a[104:105], v46 offset:34816
  ds_read_b64_tr_b16 a[106:107], v46 offset:35840
  ds_read_b64_tr_b16 a[108:109], v47 offset:34816
  ds_read_b64_tr_b16 a[110:111], v47 offset:35840
  v_exp_f32 v144, v144
  v_exp_f32_e64 v145, v145
  v_mfma_f32_32x32x16_bf16 v[18:33], a[236:239], v[132:135], v[18:33]
  v_exp_f32 v146, v146
  v_exp_f32_e64 v147, v147
  s_waitcnt lgkmcnt(0)
  s_add_u32 m0, s56, 98304
  s_add_u32 s93, s101, 28672
  buffer_load_dwordx4 v74, s[36:39], s93 offen offset:0 lds
  v_exp_f32 v148, v148
  v_exp_f32 v149, v149
  v_exp_f32 v150, v150
  v_exp_f32 v151, v151
  buffer_load_dwordx4 v75, s[36:39], s93 offen offset:1024 lds
  v_cvt_pk_bf16_f32 v144, v144, v145
  v_cvt_pk_bf16_f32 v145, v146, v147
  v_cvt_pk_bf16_f32 v146, v148, v149
  v_cvt_pk_bf16_f32 v147, v150, v151
  v_exp_f32 v152, v152
  v_exp_f32 v153, v153
  v_mfma_f32_32x32x16_bf16 v[18:33], a[240:243], v[144:147], v[18:33]
  v_exp_f32 v154, v154
  v_exp_f32 v155, v155
  buffer_load_dwordx4 v76, s[36:39], s93 offen offset:2048 lds
  v_exp_f32 v156, v156
  v_exp_f32 v157, v157
  v_exp_f32 v158, v158
  v_exp_f32 v159, v159
  buffer_load_dwordx4 v77, s[36:39], s93 offen offset:3072 lds
  v_cvt_pk_bf16_f32 v148, v152, v153
  v_cvt_pk_bf16_f32 v149, v154, v155
  v_cvt_pk_bf16_f32 v150, v156, v157
  v_cvt_pk_bf16_f32 v151, v158, v159
  ds_read_b64_tr_b16 a[232:233], v43 offset:1024
  ds_read_b64_tr_b16 a[234:235], v43 offset:1088
  ds_read_b64_tr_b16 a[236:237], v43 offset:1152
  ds_read_b64_tr_b16 a[238:239], v43 offset:1216
  v_exp_f32 v160, v160
  v_exp_f32 v161, v161
  v_mfma_f32_32x32x16_bf16 v[18:33], a[244:247], v[148:151], v[18:33]
  v_exp_f32 v162, v162
  v_exp_f32 v163, v163
  s_add_u32 m0, s56, 114688
  s_mul_i32 s93, s3, 28672
  s_add_u32 s93, s93, 0
  buffer_load_dwordx4 v74, s[40:43], s93 offen offset:0 lds
  v_exp_f32 v164, v164
  v_exp_f32 v165, v165
  v_exp_f32 v166, v166
  v_exp_f32_e64 v167, v167
  buffer_load_dwordx4 v75, s[40:43], s93 offen offset:1024 lds
  v_cvt_pk_bf16_f32 v160, v160, v161
  v_cvt_pk_bf16_f32 v161, v162, v163
  v_cvt_pk_bf16_f32 v162, v164, v165
  v_cvt_pk_bf16_f32 v163, v166, v167
  v_exp_f32 v168, v168
  v_exp_f32 v169, v169
  v_mfma_f32_32x32x16_bf16 v[18:33], a[224:227], v[160:163], v[18:33]
  v_exp_f32 v170, v170
  v_exp_f32 v171, v171
  buffer_load_dwordx4 v76, s[40:43], s93 offen offset:2048 lds
  v_exp_f32 v172, v172
  v_exp_f32 v173, v173
  v_exp_f32 v174, v174
  v_exp_f32 v175, v175
  buffer_load_dwordx4 v77, s[40:43], s93 offen offset:3072 lds
  v_cvt_pk_bf16_f32 v164, v168, v169
  v_cvt_pk_bf16_f32 v165, v170, v171
  v_cvt_pk_bf16_f32 v166, v172, v173
  v_cvt_pk_bf16_f32 v167, v174, v175
  ds_read_b64_tr_b16 a[240:241], v43 offset:1280
  ds_read_b64_tr_b16 a[242:243], v43 offset:1344
  ds_read_b64_tr_b16 a[244:245], v43 offset:1408
  ds_read_b64_tr_b16 a[246:247], v43 offset:1472
  v_exp_f32 v176, v176
  v_exp_f32 v177, v177
  v_mfma_f32_32x32x16_bf16 v[18:33], a[228:231], v[164:167], v[18:33]
  v_exp_f32 v178, v178
  v_exp_f32_e64 v179, v179
  s_lshl_b32 s93, s3, 11
  s_add_u32 m0, s93, 131072
  s_mul_i32 s93, s3, 14336
  s_add_u32 s93, s93, 114688
  buffer_load_dwordx4 v74, s[40:43], s93 offen lds
  v_exp_f32 v180, v180
  v_exp_f32 v181, v181
  v_exp_f32 v182, v182
  v_exp_f32 v183, v183
  buffer_load_dwordx4 v75, s[40:43], s93 offen offset:1024 lds
  v_cvt_pk_bf16_f32 v176, v176, v177
  v_cvt_pk_bf16_f32 v177, v178, v179
  v_cvt_pk_bf16_f32 v178, v180, v181
  v_cvt_pk_bf16_f32 v179, v182, v183
  v_exp_f32 v184, v184
  v_exp_f32_e64 v185, v185
  s_waitcnt lgkmcnt(4)
  v_mfma_f32_32x32x16_bf16 v[18:33], a[232:235], v[176:179], v[18:33]
  v_exp_f32 v186, v186
  v_exp_f32 v187, v187
  s_cmp_ge_u32 s71, 7
  s_cbranch_scc1 L_noh_31
  s_waitcnt lgkmcnt(0)
  s_and_b32 s16, s16, s17
  s_and_b32 s16, s16, 16843009
  s_cmp_eq_u32 s16, 16843009
  s_cbranch_scc1 L_ok_25
  s_mov_b32 s94, 0
L_spin_26:
  s_sleep 4
  s_load_dwordx2 s[16:17], s[66:67], 0 glc
  s_add_u32 s94, s94, 1
  s_cmp_gt_u32 s94, 3145728
  s_cbranch_scc1 L_ok_25
  s_waitcnt lgkmcnt(0)
  s_and_b32 s16, s16, s17
  s_and_b32 s16, s16, 16843009
  s_cmp_eq_u32 s16, 16843009
  s_cbranch_scc0 L_spin_26
L_ok_25:
L_noh_31:
  s_mov_b32 s58, s96
  buffer_load_dwordx4 a[112:115], v50, s[12:15], s58 offen offset:0 sc1
  v_exp_f32 v188, v188
  v_exp_f32 v189, v189
  v_exp_f32 v190, v190
  v_exp_f32 v191, v191
  s_add_u32 s59, s58, s78
  buffer_load_dwordx4 a[116:119], v50, s[12:15], s59 offen offset:0 sc1
  v_cvt_pk_bf16_f32 v180, v184, v185
  v_cvt_pk_bf16_f32 v181, v186, v187
  v_cvt_pk_bf16_f32 v182, v188, v189
  v_cvt_pk_bf16_f32 v183, v190, v191
  ds_read_b64_tr_b16 a[224:225], v43 offset:1536
  ds_read_b64_tr_b16 a[226:227], v43 offset:1600
  ds_read_b64_tr_b16 a[228:229], v43 offset:1664
  ds_read_b64_tr_b16 a[230:231], v43 offset:1728
  v_exp_f32 v192, v192
  v_exp_f32 v193, v193
  v_mfma_f32_32x32x16_bf16 v[18:33], a[236:239], v[180:183], v[18:33]
  v_exp_f32 v194, v194
  v_exp_f32 v195, v195
  buffer_load_dwordx4 a[120:123], v50, s[12:15], s58 offen offset:1024 sc1
  v_exp_f32 v196, v196
  v_exp_f32 v197, v197
  v_exp_f32 v198, v198
  v_exp_f32 v199, v199
  buffer_load_dwordx4 a[124:127], v50, s[12:15], s59 offen offset:1024 sc1
  v_cvt_pk_bf16_f32 v192, v192, v193
  v_cvt_pk_bf16_f32 v193, v194, v195
  v_cvt_pk_bf16_f32 v194, v196, v197
  v_cvt_pk_bf16_f32 v195, v198, v199
  v_exp_f32 v200, v200
  v_exp_f32 v201, v201
  v_mfma_f32_32x32x16_bf16 v[18:33], a[240:243], v[192:195], v[18:33]
  v_exp_f32 v202, v202
  v_exp_f32 v203, v203
  buffer_load_dwordx4 a[128:131], v50, s[12:15], s58 offen offset:2048 sc1
  v_exp_f32 v204, v204
  v_exp_f32 v205, v205
  v_exp_f32 v206, v206
  v_exp_f32 v207, v207
  buffer_load_dwordx4 a[132:135], v50, s[12:15], s59 offen offset:2048 sc1
  v_cvt_pk_bf16_f32 v196, v200, v201
  v_cvt_pk_bf16_f32 v197, v202, v203
  v_cvt_pk_bf16_f32 v198, v204, v205
  v_cvt_pk_bf16_f32 v199, v206, v207
  ds_read_b64_tr_b16 a[232:233], v43 offset:1792
  ds_read_b64_tr_b16 a[234:235], v43 offset:1856
  ds_read_b64_tr_b16 a[236:237], v43 offset:1920
  ds_read_b64_tr_b16 a[238:239], v43 offset:1984
  v_exp_f32 v208, v208
  v_exp_f32 v209, v209
  v_mfma_f32_32x32x16_bf16 v[18:33], a[244:247], v[196:199], v[18:33]
  v_exp_f32 v210, v210
  v_exp_f32 v211, v211
  buffer_load_dwordx4 a[136:139], v50, s[12:15], s58 offen offset:3072 sc1
  v_exp_f32 v212, v212
  v_exp_f32 v213, v213
  v_exp_f32 v214, v214
  v_exp_f32 v215, v215
  buffer_load_dwordx4 a[140:143], v50, s[12:15], s59 offen offset:3072 sc1
  v_cvt_pk_bf16_f32 v208, v208, v209
  v_cvt_pk_bf16_f32 v209, v210, v211
  v_cvt_pk_bf16_f32 v210, v212, v213
  v_cvt_pk_bf16_f32 v211, v214, v215
  v_exp_f32 v216, v216
  v_exp_f32_e64 v217, v217
  s_waitcnt lgkmcnt(4)
  v_mfma_f32_32x32x16_bf16 v[18:33], a[224:227], v[208:211], v[18:33]
  v_exp_f32 v218, v218
  v_exp_f32 v219, v219
  s_add_u32 s58, s96, 8192
  buffer_load_dwordx4 a[144:147], v50, s[12:15], s58 offen offset:0 sc1
  v_exp_f32 v220, v220
  v_exp_f32 v221, v221
  v_exp_f32 v222, v222
  v_exp_f32_e64 v223, v223
  s_add_u32 s59, s58, s78
  buffer_load_dwordx4 a[148:151], v50, s[12:15], s59 offen offset:0 sc1
  v_cvt_pk_bf16_f32 v212, v216, v217
  v_cvt_pk_bf16_f32 v213, v218, v219
  v_cvt_pk_bf16_f32 v214, v220, v221
  v_cvt_pk_bf16_f32 v215, v222, v223
  ds_read_b64_tr_b16 a[240:241], v43 offset:2048
  ds_read_b64_tr_b16 a[242:243], v43 offset:2112
  ds_read_b64_tr_b16 a[244:245], v43 offset:2176
  ds_read_b64_tr_b16 a[246:247], v43 offset:2240
  v_exp_f32 v224, v224
  v_exp_f32 v225, v225
  v_mfma_f32_32x32x16_bf16 v[18:33], a[228:231], v[212:215], v[18:33]
  v_exp_f32 v226, v226
  v_exp_f32 v227, v227
  buffer_load_dwordx4 a[152:155], v50, s[12:15], s58 offen offset:1024 sc1
  v_exp_f32 v228, v228
  v_exp_f32 v229, v229
  v_exp_f32 v230, v230
  v_exp_f32 v231, v231
  buffer_load_dwordx4 a[156:159], v50, s[12:15], s59 offen offset:1024 sc1
  v_cvt_pk_bf16_f32 v224, v224, v225
  v_cvt_pk_bf16_f32 v225, v226, v227
  v_cvt_pk_bf16_f32 v226, v228, v229
  v_cvt_pk_bf16_f32 v227, v230, v231
  v_exp_f32 v232, v232
  v_exp_f32_e64 v233, v233
  s_waitcnt lgkmcnt(4)
  v_mfma_f32_32x32x16_bf16 v[18:33], a[232:235], v[224:227], v[18:33]
  v_exp_f32 v234, v234
  v_exp_f32 v235, v235
  buffer_load_dwordx4 a[160:163], v50, s[12:15], s58 offen offset:2048 sc1
  v_exp_f32 v236, v236
  v_exp_f32 v237, v237
  v_exp_f32 v238, v238
  v_exp_f32 v239, v239
  buffer_load_dwordx4 a[164:167], v50, s[12:15], s59 offen offset:2048 sc1
  v_cvt_pk_bf16_f32 v228, v232, v233
  v_cvt_pk_bf16_f32 v229, v234, v235
  v_cvt_pk_bf16_f32 v230, v236, v237
  v_cvt_pk_bf16_f32 v231, v238, v239
  s_load_dwordx2 s[16:17], s[66:67], 0 glc
  v_exp_f32 v112, v112
  v_exp_f32 v113, v113
  v_mfma_f32_32x32x16_bf16 v[18:33], a[236:239], v[228:231], v[18:33]
  v_exp_f32 v114, v114
  v_exp_f32 v115, v115
  buffer_load_dwordx4 a[168:171], v50, s[12:15], s58 offen offset:3072 sc1
  v_exp_f32 v116, v116
  v_exp_f32 v117, v117
  v_exp_f32 v118, v118
  v_exp_f32 v119, v119
  buffer_load_dwordx4 a[172:175], v50, s[12:15], s59 offen offset:3072 sc1
  v_cvt_pk_bf16_f32 v112, v112, v113
  v_cvt_pk_bf16_f32 v113, v114, v115
  v_cvt_pk_bf16_f32 v114, v116, v117
  v_cvt_pk_bf16_f32 v115, v118, v119
  v_exp_f32 v120, v120
  v_exp_f32_e64 v121, v121
  s_waitcnt lgkmcnt(0)
  v_mfma_f32_32x32x16_bf16 v[18:33], a[240:243], v[112:115], v[18:33]
  v_exp_f32 v122, v122
  v_exp_f32 v123, v123
  s_add_u32 s58, s96, 16384
  buffer_load_dwordx4 a[176:179], v50, s[12:15], s58 offen offset:0 sc1
  v_exp_f32 v124, v124
  v_exp_f32 v125, v125
  v_exp_f32 v126, v126
  v_exp_f32_e64 v127, v127
  s_add_u32 s59, s58, s78
  buffer_load_dwordx4 a[180:183], v50, s[12:15], s59 offen offset:0 sc1
  v_cvt_pk_bf16_f32 v116, v120, v121
  v_cvt_pk_bf16_f32 v117, v122, v123
  v_cvt_pk_bf16_f32 v118, v124, v125
  v_cvt_pk_bf16_f32 v119, v126, v127
  s_nop 1
  v_mfma_f32_32x32x16_bf16 v[18:33], a[244:247], v[116:119], v[18:33]
  s_mul_i32 s57, s5, 116480
  s_lshl2_add_u32 s60, s4, s3
  s_lshl_b32 s60, s60, 8
  s_add_u32 s57, s57, s60
  v_lshlrev_b32_e64 v65, 3, v53
  v_mul_u32_u24 v66, 16640, v51
  v_add_u32_e64 v66, v66, v65
  v_mul_u32_u24 v67, 16777200, v51
  v_lshl_add_u32 v67, v67, 6, v65
  buffer_load_dwordx4 a[184:187], v50, s[12:15], s58 offen offset:1024 sc1
  buffer_load_dwordx4 a[188:191], v50, s[12:15], s59 offen offset:1024 sc1
  s_nop 0
  v_mov_b32 v54, v30
  v_mov_b32_e64 v55, v30
  buffer_load_dwordx4 a[192:195], v50, s[12:15], s58 offen offset:2048 sc1
  s_nop 0
  v_permlane32_swap_b32 v54, v55
  v_rcp_f32 v55, v55
  s_nop 0
  v_mov_b32_e64 v54, v55
  v_pk_mul_f32 v[18:19], v[18:19], v[54:55]
  v_pk_mul_f32 v[20:21], v[20:21], v[54:55]
  v_pk_mul_f32 v[22:23], v[22:23], v[54:55]
  v_pk_mul_f32 v[24:25], v[24:25], v[54:55]
  v_pk_mul_f32 v[26:27], v[26:27], v[54:55]
  v_pk_mul_f32 v[28:29], v[28:29], v[54:55]
  v_pk_mul_f32 v[30:31], v[30:31], v[54:55]
  v_pk_mul_f32 v[32:33], v[32:33], v[54:55]
  buffer_load_dwordx4 a[196:199], v50, s[12:15], s59 offen offset:2048 sc1
  v_cvt_pk_bf16_f32 v18, v18, v19
  v_cvt_pk_bf16_f32 v19, v20, v21
  v_cvt_pk_bf16_f32 v20, v22, v23
  v_cvt_pk_bf16_f32 v21, v24, v25
  v_cvt_pk_bf16_f32 v22, v26, v27
  v_cvt_pk_bf16_f32 v23, v28, v29
  v_cvt_pk_bf16_f32 v24, v30, v31
  v_cvt_pk_bf16_f32 v25, v32, v33
  s_add_u32 s60, s57, 6291456
  buffer_store_dwordx2 v[18:19], v66, s[12:15], s60 offen sc1
  s_add_u32 s60, s57, 6324736
  buffer_store_dwordx2 v[20:21], v66, s[12:15], s60 offen sc1
  s_add_u32 s60, s57, 6358016
  buffer_store_dwordx2 v[22:23], v66, s[12:15], s60 offen sc1
  s_add_u32 s60, s57, 6391296
  buffer_store_dwordx2 v[24:25], v67, s[12:15], s60 offen sc1
  s_cmp_lt_u32 s71, 7
  s_cbranch_scc1 L_g2_32
  s_waitcnt vmcnt(0)
  buffer_store_byte v79, v95, s[12:15], 0 offen sc1
  s_branch L_fin
L_g2_32:
  s_waitcnt vmcnt(24)
  v_mfma_f32_32x32x16_bf16 v[128:143], a[0:3], a[112:115], 0
  v_mul_u32_u24 v65, 16640, v51
  v_lshl_add_u32 v2, v53, 4, v65
  v_add_u32 v3, 32256, v2
  v_add_u32 v4, 64512, v2
  v_add_u32 v5, 96768, v2
  v_mfma_f32_32x32x16_bf16 v[144:159], a[0:3], a[116:119], 0
  buffer_load_dwordx4 a[200:203], v50, s[12:15], s58 offen offset:3072 sc1
  v_lshl_add_u32 v6, v1, 3, s56
  v_add_u32 v7, 0x10000, v6
  v_mfma_f32_32x32x16_bf16 v[160:175], a[4:7], a[112:115], 0
  buffer_load_dwordx4 a[204:207], v50, s[12:15], s59 offen offset:3072 sc1
  s_lshl_b32 s57, s6, 8
  v_lshlrev_b32_e64 v9, 3, v53
  v_mfma_f32_32x32x16_bf16 v[176:191], a[4:7], a[116:119], 0
  v_lshl_add_u32 v9, v51, 9, v9
  v_add_u32_e64 v8, s57, v9
  v_add_u32 v9, 0x10000, v8
  v_add_u32 v11, 0x10000, v92
  v_add_u32 v12, 0x20000, v92
  s_waitcnt vmcnt(24)
  v_mfma_f32_32x32x16_bf16 v[128:143], a[8:11], a[120:123], v[128:143]
  v_xor_b32 v54, 4096, v6
  v_xor_b32 v55, 4096, v7
  v_xor_b32 v56, 8192, v6
  v_xor_b32 v57, 8192, v7
  v_xor_b32 v58, 12288, v6
  v_mfma_f32_32x32x16_bf16 v[144:159], a[8:11], a[124:127], v[144:159]
  s_waitcnt lgkmcnt(0)
  s_and_b32 s16, s16, s17
  s_and_b32 s16, s16, 33686018
  s_cmp_eq_u32 s16, 33686018
  s_cbranch_scc1 L_ok_27
  s_mov_b32 s94, 0
L_spin_28:
  s_sleep 4
  s_load_dwordx2 s[16:17], s[66:67], 0 glc
  s_add_u32 s94, s94, 1
  s_cmp_gt_u32 s94, 3145728
  s_cbranch_scc1 L_ok_27
  s_waitcnt lgkmcnt(0)
  s_and_b32 s16, s16, s17
  s_and_b32 s16, s16, 33686018
  s_cmp_eq_u32 s16, 33686018
  s_cbranch_scc0 L_spin_28
L_ok_27:
  s_add_u32 s58, s96, 4096
  buffer_load_dwordx4 a[208:211], v50, s[12:15], s58 offen offset:0 sc1
  v_xor_b32 v59, 12288, v7
  v_accvgpr_read_b32 v224, a248
  v_mfma_f32_32x32x16_bf16 v[160:175], a[12:15], a[120:123], v[160:175]
  s_add_u32 s59, s58, s78
  buffer_load_dwordx4 a[212:215], v50, s[12:15], s59 offen offset:0 sc1
  v_accvgpr_read_b32 v225, a249
  v_accvgpr_read_b32 v226, a250
  v_mfma_f32_32x32x16_bf16 v[176:191], a[12:15], a[124:127], v[176:191]
  v_accvgpr_read_b32 v227, a251
  v_accvgpr_read_b32 v228, a252
  v_accvgpr_read_b32 v229, a253
  v_accvgpr_read_b32 v230, a254
  v_accvgpr_read_b32 v231, a255
  s_waitcnt vmcnt(24)
  v_mfma_f32_32x32x16_bf16 v[128:143], a[16:19], a[128:131], v[128:143]
  v_permlane32_swap_b32 v224, v226
  v_permlane32_swap_b32 v225, v227
  v_permlane32_swap_b32 v228, v230
  v_permlane32_swap_b32 v229, v231
  v_lshlrev_b32 v208, 16, v224
  v_mfma_f32_32x32x16_bf16 v[144:159], a[16:19], a[132:135], v[144:159]
  buffer_load_dwordx4 a[216:219], v50, s[12:15], s58 offen offset:1024 sc1
  v_and_b32 v209, 0xffff0000, v224
  v_lshlrev_b32_e64 v210, 16, v225
  v_mfma_f32_32x32x16_bf16 v[160:175], a[20:23], a[128:131], v[160:175]
  buffer_load_dwordx4 a[220:223], v50, s[12:15], s59 offen offset:1024 sc1
  v_and_b32 v211, 0xffff0000, v225
  v_lshlrev_b32_e64 v212, 16, v226
  v_mfma_f32_32x32x16_bf16 v[176:191], a[20:23], a[132:135], v[176:191]
  v_and_b32 v213, 0xffff0000, v226
  v_lshlrev_b32_e64 v214, 16, v227
  v_and_b32 v215, 0xffff0000, v227
  v_lshlrev_b32_e64 v216, 16, v228
  v_and_b32 v217, 0xffff0000, v228
  s_waitcnt vmcnt(24)
  v_mfma_f32_32x32x16_bf16 v[128:143], a[24:27], a[136:139], v[128:143]
  v_lshlrev_b32 v218, 16, v229
  v_and_b32 v219, 0xffff0000, v229
  v_lshlrev_b32_e64 v220, 16, v230
  v_and_b32 v221, 0xffff0000, v230
  v_lshlrev_b32_e64 v222, 16, v231
  v_mfma_f32_32x32x16_bf16 v[144:159], a[24:27], a[140:143], v[144:159]
  buffer_load_dwordx4 a[112:115], v50, s[12:15], s58 offen offset:2048 sc1
  v_and_b32 v223, 0xffff0000, v231
  s_mul_i32 s76, s3, 465920
  v_mfma_f32_32x32x16_bf16 v[160:175], a[28:31], a[136:139], v[160:175]
  buffer_load_dwordx4 a[116:119], v50, s[12:15], s59 offen offset:2048 sc1
  s_lshl_b32 s77, s70, 9
  s_add_u32 s76, s76, s77
  v_mfma_f32_32x32x16_bf16 v[176:191], a[28:31], a[140:143], v[176:191]
  s_waitcnt vmcnt(24)
  v_mfma_f32_32x32x16_bf16 v[128:143], a[32:35], a[144:147], v[128:143]
  v_mfma_f32_32x32x16_bf16 v[144:159], a[32:35], a[148:151], v[144:159]
  buffer_load_dwordx4 a[120:123], v50, s[12:15], s58 offen offset:3072 sc1
  v_mfma_f32_32x32x16_bf16 v[160:175], a[36:39], a[144:147], v[160:175]
  buffer_load_dwordx4 a[124:127], v50, s[12:15], s59 offen offset:3072 sc1
  v_mfma_f32_32x32x16_bf16 v[176:191], a[36:39], a[148:151], v[176:191]
  s_barrier
  s_waitcnt vmcnt(24)
  v_mfma_f32_32x32x16_bf16 v[128:143], a[40:43], a[152:155], v[128:143]
  s_waitcnt vmcnt(10)
  buffer_store_byte v79, v95, s[12:15], 0 offen sc1
  v_mfma_f32_32x32x16_bf16 v[144:159], a[40:43], a[156:159], v[144:159]
  s_lshl_b32 s93, s3, 11
  s_add_u32 m0, s93, 139264
  s_mul_i32 s93, s3, 14336
  s_add_u32 s93, s93, 172032
  buffer_load_dwordx4 v74, s[40:43], s93 offen lds
  v_mfma_f32_32x32x16_bf16 v[160:175], a[44:47], a[152:155], v[160:175]
  buffer_load_dwordx4 v75, s[40:43], s93 offen offset:1024 lds
  v_mfma_f32_32x32x16_bf16 v[176:191], a[44:47], a[156:159], v[176:191]
  ds_read_b64_tr_b16 a[0:1], v11 offset:49152
  ds_read_b64_tr_b16 a[2:3], v11 offset:50176
  ds_read_b64_tr_b16 a[4:5], v11 offset:51200
  ds_read_b64_tr_b16 a[6:7], v11 offset:52224
  v_mfma_f32_32x32x16_bf16 v[128:143], a[48:51], a[160:163], v[128:143]
  ds_read_b64_tr_b16 a[8:9], v11 offset:53248
  ds_read_b64_tr_b16 a[10:11], v11 offset:54272
  ds_read_b64_tr_b16 a[12:13], v11 offset:55296
  ds_read_b64_tr_b16 a[14:15], v11 offset:56320
  v_mfma_f32_32x32x16_bf16 v[144:159], a[48:51], a[164:167], v[144:159]
  s_add_u32 m0, s56, 147456
  s_mul_i32 s93, s3, 28672
  s_add_u32 s93, s93, 229376
  buffer_load_dwordx4 v74, s[40:43], s93 offen offset:0 lds
  v_mfma_f32_32x32x16_bf16 v[160:175], a[52:55], a[160:163], v[160:175]
  buffer_load_dwordx4 v75, s[40:43], s93 offen offset:1024 lds
  v_mfma_f32_32x32x16_bf16 v[176:191], a[52:55], a[164:167], v[176:191]
  ds_read_b64_tr_b16 a[16:17], v11 offset:57344
  ds_read_b64_tr_b16 a[18:19], v11 offset:58368
  ds_read_b64_tr_b16 a[20:21], v11 offset:59392
  ds_read_b64_tr_b16 a[22:23], v11 offset:60416
  v_mfma_f32_32x32x16_bf16 v[128:143], a[56:59], a[168:171], v[128:143]
  ds_read_b64_tr_b16 a[24:25], v11 offset:61440
  ds_read_b64_tr_b16 a[26:27], v11 offset:62464
  ds_read_b64_tr_b16 a[28:29], v11 offset:63488
  ds_read_b64_tr_b16 a[30:31], v11 offset:64512
  v_mfma_f32_32x32x16_bf16 v[144:159], a[56:59], a[172:175], v[144:159]
  buffer_load_dwordx4 v76, s[40:43], s93 offen offset:2048 lds
  v_mfma_f32_32x32x16_bf16 v[160:175], a[60:63], a[168:171], v[160:175]
  buffer_load_dwordx4 v77, s[40:43], s93 offen offset:3072 lds
  v_mfma_f32_32x32x16_bf16 v[176:191], a[60:63], a[172:175], v[176:191]
  ds_read_b64_tr_b16 a[32:33], v12 offset:0
  ds_read_b64_tr_b16 a[34:35], v12 offset:1024
  ds_read_b64_tr_b16 a[36:37], v12 offset:2048
  ds_read_b64_tr_b16 a[38:39], v12 offset:3072
  v_mfma_f32_32x32x16_bf16 v[128:143], a[64:67], a[176:179], v[128:143]
  ds_read_b64_tr_b16 a[40:41], v12 offset:4096
  ds_read_b64_tr_b16 a[42:43], v12 offset:5120
  ds_read_b64_tr_b16 a[44:45], v12 offset:6144
  ds_read_b64_tr_b16 a[46:47], v12 offset:7168
  v_mfma_f32_32x32x16_bf16 v[144:159], a[64:67], a[180:183], v[144:159]
  s_add_u32 s58, s96, 12288
  buffer_load_dwordx4 a[128:131], v50, s[12:15], s58 offen offset:0 sc1
  v_mfma_f32_32x32x16_bf16 v[160:175], a[68:71], a[176:179], v[160:175]
  s_add_u32 s59, s58, s78
  buffer_load_dwordx4 a[132:135], v50, s[12:15], s59 offen offset:0 sc1
  v_mfma_f32_32x32x16_bf16 v[176:191], a[68:71], a[180:183], v[176:191]
  v_mfma_f32_32x32x16_bf16 v[128:143], a[72:75], a[184:187], v[128:143]
  v_mfma_f32_32x32x16_bf16 v[144:159], a[72:75], a[188:191], v[144:159]
  buffer_load_dwordx4 a[136:139], v50, s[12:15], s58 offen offset:1024 sc1
  v_mfma_f32_32x32x16_bf16 v[160:175], a[76:79], a[184:187], v[160:175]
  buffer_load_dwordx4 a[140:143], v50, s[12:15], s59 offen offset:1024 sc1
  v_mfma_f32_32x32x16_bf16 v[176:191], a[76:79], a[188:191], v[176:191]
  v_mfma_f32_32x32x16_bf16 v[128:143], a[80:83], a[192:195], v[128:143]
  v_mfma_f32_32x32x16_bf16 v[144:159], a[80:83], a[196:199], v[144:159]
  buffer_load_dwordx4 a[144:147], v50, s[12:15], s58 offen offset:2048 sc1
  v_mfma_f32_32x32x16_bf16 v[160:175], a[84:87], a[192:195], v[160:175]
  buffer_load_dwordx4 a[148:151], v50, s[12:15], s59 offen offset:2048 sc1
  v_mfma_f32_32x32x16_bf16 v[176:191], a[84:87], a[196:199], v[176:191]
  s_waitcnt vmcnt(21)
  v_mfma_f32_32x32x16_bf16 v[128:143], a[88:91], a[200:203], v[128:143]
  ds_read_b64_tr_b16 v[112:113], v44 offset:32768
  ds_read_b64_tr_b16 v[114:115], v44 offset:33792
  ds_read_b64_tr_b16 v[116:117], v45 offset:32768
  ds_read_b64_tr_b16 v[118:119], v45 offset:33792
  v_mfma_f32_32x32x16_bf16 v[144:159], a[88:91], a[204:207], v[144:159]
  buffer_load_dwordx4 a[152:155], v50, s[12:15], s58 offen offset:3072 sc1
  v_mfma_f32_32x32x16_bf16 v[160:175], a[92:95], a[200:203], v[160:175]
  buffer_load_dwordx4 a[156:159], v50, s[12:15], s59 offen offset:3072 sc1
  v_mfma_f32_32x32x16_bf16 v[176:191], a[92:95], a[204:207], v[176:191]
  ds_read_b64_tr_b16 v[120:121], v44 offset:34816
  ds_read_b64_tr_b16 v[122:123], v44 offset:35840
  ds_read_b64_tr_b16 v[124:125], v45 offset:34816
  ds_read_b64_tr_b16 v[126:127], v45 offset:35840
  s_waitcnt vmcnt(21)
  v_mfma_f32_32x32x16_bf16 v[128:143], a[96:99], a[208:211], v[128:143]
  ds_read_b64_tr_b16 v[18:19], v44 offset:0
  ds_read_b64_tr_b16 v[20:21], v44 offset:1024
  ds_read_b64_tr_b16 v[22:23], v45 offset:0
  ds_read_b64_tr_b16 v[24:25], v45 offset:1024
  v_mfma_f32_32x32x16_bf16 v[144:159], a[96:99], a[212:215], v[144:159]
  s_add_u32 s58, s96, 20480
  buffer_load_dwordx4 a[160:163], v50, s[12:15], s58 offen offset:0 sc1
  v_mfma_f32_32x32x16_bf16 v[160:175], a[100:103], a[208:211], v[160:175]
  s_add_u32 s59, s58, s78
  buffer_load_dwordx4 a[164:167], v50, s[12:15], s59 offen offset:0 sc1
  v_mfma_f32_32x32x16_bf16 v[176:191], a[100:103], a[212:215], v[176:191]
  ds_read_b64_tr_b16 v[26:27], v44 offset:2048
  ds_read_b64_tr_b16 v[28:29], v44 offset:3072
  ds_read_b64_tr_b16 v[30:31], v45 offset:2048
  ds_read_b64_tr_b16 v[32:33], v45 offset:3072
  s_waitcnt vmcnt(21)
  v_mfma_f32_32x32x16_bf16 v[128:143], a[104:107], a[216:219], v[128:143]
  ds_read_b64_tr_b16 v[34:35], v44 offset:16384
  ds_read_b64_tr_b16 v[36:37], v44 offset:17408
  ds_read_b64_tr_b16 v[38:39], v45 offset:16384
  ds_read_b64_tr_b16 v[40:41], v45 offset:17408
  v_mfma_f32_32x32x16_bf16 v[144:159], a[104:107], a[220:223], v[144:159]
  buffer_load_dwordx4 a[168:171], v50, s[12:15], s58 offen offset:1024 sc1
  v_mfma_f32_32x32x16_bf16 v[160:175], a[108:111], a[216:219], v[160:175]
  buffer_load_dwordx4 a[172:175], v50, s[12:15], s59 offen offset:1024 sc1
  v_mfma_f32_32x32x16_bf16 v[176:191], a[108:111], a[220:223], v[176:191]
  ds_read_b64_tr_b16 v[192:193], v44 offset:18432
  ds_read_b64_tr_b16 v[194:195], v44 offset:19456
  ds_read_b64_tr_b16 v[196:197], v45 offset:18432
  ds_read_b64_tr_b16 v[198:199], v45 offset:19456
  s_waitcnt lgkmcnt(15)
  s_waitcnt vmcnt(21)
  v_mfma_f32_32x32x16_bf16 v[128:143], v[112:115], a[112:115], v[128:143]
  ds_read_b64_tr_b16 v[200:201], v44 offset:49152
  ds_read_b64_tr_b16 v[202:203], v44 offset:50176
  ds_read_b64_tr_b16 v[204:205], v45 offset:49152
  ds_read_b64_tr_b16 v[206:207], v45 offset:50176
  v_mfma_f32_32x32x16_bf16 v[144:159], v[112:115], a[116:119], v[144:159]
  buffer_load_dwordx4 a[176:179], v50, s[12:15], s58 offen offset:2048 sc1
  s_load_dwordx2 s[16:17], s[66:67], 8 glc
  v_mfma_f32_32x32x16_bf16 v[160:175], v[116:119], a[112:115], v[160:175]
  buffer_load_dwordx4 a[180:183], v50, s[12:15], s59 offen offset:2048 sc1
  v_mfma_f32_32x32x16_bf16 v[176:191], v[116:119], a[116:119], v[176:191]
  ds_read_b64_tr_b16 v[232:233], v44 offset:51200
  ds_read_b64_tr_b16 v[234:235], v44 offset:52224
  ds_read_b64_tr_b16 v[236:237], v45 offset:51200
  ds_read_b64_tr_b16 v[238:239], v45 offset:52224
  s_waitcnt lgkmcnt(15)
  s_waitcnt vmcnt(21)
  v_mfma_f32_32x32x16_bf16 v[128:143], v[120:123], a[120:123], v[128:143]
  ds_read_b64_tr_b16 v[240:241], v46 offset:16384
  ds_read_b64_tr_b16 v[242:243], v46 offset:17408
  ds_read_b64_tr_b16 v[244:245], v47 offset:16384
  ds_read_b64_tr_b16 v[246:247], v47 offset:17408
  v_mfma_f32_32x32x16_bf16 v[144:159], v[120:123], a[124:127], v[144:159]
  buffer_load_dwordx4 a[184:187], v50, s[12:15], s58 offen offset:3072 sc1
  v_mfma_f32_32x32x16_bf16 v[160:175], v[124:127], a[120:123], v[160:175]
  buffer_load_dwordx4 a[188:191], v50, s[12:15], s59 offen offset:3072 sc1
  v_mfma_f32_32x32x16_bf16 v[176:191], v[124:127], a[124:127], v[176:191]
  ds_read_b64_tr_b16 v[248:249], v46 offset:18432
  ds_read_b64_tr_b16 v[250:251], v46 offset:19456
  ds_read_b64_tr_b16 v[252:253], v47 offset:18432
  ds_read_b64_tr_b16 v[254:255], v47 offset:19456
  s_waitcnt vmcnt(16)
  s_barrier
  s_waitcnt lgkmcnt(15)
  s_waitcnt vmcnt(14)
  v_mfma_f32_32x32x16_bf16 v[128:143], v[18:21], a[128:131], v[128:143]
  ds_read_b64_tr_b16 v[96:97], v46 offset:0
  ds_read_b64_tr_b16 v[98:99], v46 offset:1024
  ds_read_b64_tr_b16 v[100:101], v47 offset:0
  ds_read_b64_tr_b16 v[102:103], v47 offset:1024
  v_mfma_f32_32x32x16_bf16 v[144:159], v[18:21], a[132:135], v[144:159]
  s_mov_b32 s58, s97
  buffer_load_dwordx4 a[192:195], v50, s[12:15], s58 offen offset:0 sc1
  v_mfma_f32_32x32x16_bf16 v[160:175], v[22:25], a[128:131], v[160:175]
  s_add_u32 s59, s58, s78
  buffer_load_dwordx4 a[196:199], v50, s[12:15], s59 offen offset:0 sc1
  v_mfma_f32_32x32x16_bf16 v[176:191], v[22:25], a[132:135], v[176:191]
  ds_read_b64_tr_b16 v[104:105], v46 offset:2048
  ds_read_b64_tr_b16 v[106:107], v46 offset:3072
  ds_read_b64_tr_b16 v[108:109], v47 offset:2048
  ds_read_b64_tr_b16 v[110:111], v47 offset:3072
  s_waitcnt lgkmcnt(15)
  s_waitcnt vmcnt(14)
  v_mfma_f32_32x32x16_bf16 v[128:143], v[26:29], a[136:139], v[128:143]
  ds_read_b64_tr_b16 v[112:113], v46 offset:32768
  ds_read_b64_tr_b16 v[114:115], v46 offset:33792
  ds_read_b64_tr_b16 v[116:117], v47 offset:32768
  ds_read_b64_tr_b16 v[118:119], v47 offset:33792
  v_mfma_f32_32x32x16_bf16 v[144:159], v[26:29], a[140:143], v[144:159]
  buffer_load_dwordx4 a[200:203], v50, s[12:15], s58 offen offset:1024 sc1
  v_mfma_f32_32x32x16_bf16 v[160:175], v[30:33], a[136:139], v[160:175]
  buffer_load_dwordx4 a[204:207], v50, s[12:15], s59 offen offset:1024 sc1
  v_mfma_f32_32x32x16_bf16 v[176:191], v[30:33], a[140:143], v[176:191]
  ds_read_b64_tr_b16 v[120:121], v46 offset:34816
  ds_read_b64_tr_b16 v[122:123], v46 offset:35840
  ds_read_b64_tr_b16 v[124:125], v47 offset:34816
  ds_read_b64_tr_b16 v[126:127], v47 offset:35840
  s_waitcnt lgkmcnt(15)
  s_waitcnt vmcnt(14)
  v_mfma_f32_32x32x16_bf16 v[128:143], v[34:37], a[144:147], v[128:143]
  ds_read_b64_tr_b16 a[48:49], v12 offset:8192
  ds_read_b64_tr_b16 a[50:51], v12 offset:9216
  ds_read_b64_tr_b16 a[52:53], v12 offset:10240
  ds_read_b64_tr_b16 a[54:55], v12 offset:11264
  v_mfma_f32_32x32x16_bf16 v[144:159], v[34:37], a[148:151], v[144:159]
  buffer_load_dwordx4 a[208:211], v50, s[12:15], s58 offen offset:2048 sc1
  v_mfma_f32_32x32x16_bf16 v[160:175], v[38:41], a[144:147], v[160:175]
  buffer_load_dwordx4 a[212:215], v50, s[12:15], s59 offen offset:2048 sc1
  v_mfma_f32_32x32x16_bf16 v[176:191], v[38:41], a[148:151], v[176:191]
  ds_read_b64_tr_b16 a[56:57], v12 offset:12288
  ds_read_b64_tr_b16 a[58:59], v12 offset:13312
  ds_read_b64_tr_b16 a[60:61], v12 offset:14336
  ds_read_b64_tr_b16 a[62:63], v12 offset:15360
  s_waitcnt lgkmcnt(15)
  s_waitcnt vmcnt(14)
  v_mfma_f32_32x32x16_bf16 v[128:143], v[192:195], a[152:155], v[128:143]
  ds_read_b64_tr_b16 a[64:65], v12 offset:16384
  ds_read_b64_tr_b16 a[66:67], v12 offset:17408
  ds_read_b64_tr_b16 a[68:69], v12 offset:18432
  ds_read_b64_tr_b16 a[70:71], v12 offset:19456
  v_mfma_f32_32x32x16_bf16 v[144:159], v[192:195], a[156:159], v[144:159]
  buffer_load_dwordx4 a[216:219], v50, s[12:15], s58 offen offset:3072 sc1
  v_mfma_f32_32x32x16_bf16 v[160:175], v[196:199], a[152:155], v[160:175]
  buffer_load_dwordx4 a[220:223], v50, s[12:15], s59 offen offset:3072 sc1
  v_mfma_f32_32x32x16_bf16 v[176:191], v[196:199], a[156:159], v[176:191]
  ds_read_b64_tr_b16 a[72:73], v12 offset:20480
  ds_read_b64_tr_b16 a[74:75], v12 offset:21504
  ds_read_b64_tr_b16 a[76:77], v12 offset:22528
  ds_read_b64_tr_b16 a[78:79], v12 offset:23552
  s_waitcnt lgkmcnt(15)
  s_waitcnt vmcnt(14)
  v_mfma_f32_32x32x16_bf16 v[144:159], v[200:203], a[164:167], v[144:159]
  ds_read_b64_tr_b16 a[80:81], v12 offset:24576
  ds_read_b64_tr_b16 a[82:83], v12 offset:25600
  ds_read_b64_tr_b16 a[84:85], v12 offset:26624
  ds_read_b64_tr_b16 a[86:87], v12 offset:27648
  s_waitcnt vmcnt(12)
  v_mfma_f32_32x32x16_bf16 v[144:159], v[232:235], a[172:175], v[144:159]
  s_add_u32 m0, s56, 51200
  s_mul_i32 s93, s3, 14336
  s_add_u32 s93, s93, 344064
  buffer_load_dwordx4 v74, s[40:43], s93 offen lds
  ds_read_b64_tr_b16 a[88:89], v12 offset:28672
  ds_read_b64_tr_b16 a[90:91], v12 offset:29696
  s_waitcnt vmcnt(11)
  v_mfma_f32_32x32x16_bf16 v[144:159], v[240:243], a[180:183], v[144:159]
  ds_read_b64_tr_b16 a[92:93], v12 offset:30720
  ds_read_b64_tr_b16 a[94:95], v12 offset:31744
  s_waitcnt vmcnt(9)
  v_mfma_f32_32x32x16_bf16 v[144:159], v[248:251], a[188:191], v[144:159]
  buffer_load_dwordx4 v75, s[40:43], s93 offen offset:1024 lds
  s_waitcnt vmcnt(8)
  v_mfma_f32_32x32x16_bf16 v[144:159], v[96:99], a[196:199], v[144:159]
  s_waitcnt vmcnt(6)
  v_mfma_f32_32x32x16_bf16 v[144:159], v[104:107], a[204:207], v[144:159]
  s_waitcnt lgkmcnt(0)
  s_and_b32 s16, s16, s17
  s_and_b32 s16, s16, 16843009
  s_cmp_eq_u32 s16, 16843009
  s_cbranch_scc1 L_ok_29
  s_mov_b32 s94, 0
L_spin_30:
  s_sleep 4
  s_load_dwordx2 s[16:17], s[66:67], 8 glc
  s_add_u32 s94, s94, 1
  s_cmp_gt_u32 s94, 3145728
  s_cbranch_scc1 L_ok_29
  s_waitcnt lgkmcnt(0)
  s_and_b32 s16, s16, s17
  s_and_b32 s16, s16, 16843009
  s_cmp_eq_u32 s16, 16843009
  s_cbranch_scc0 L_spin_30
L_ok_29:
  s_add_u32 m0, s56, 32768
  s_add_u32 s93, s76, 6291456
  buffer_load_dwordx4 v2, s[12:15], s93 offen offset:0 sc1 lds
  s_waitcnt vmcnt(5)
  v_mfma_f32_32x32x16_bf16 v[144:159], v[112:115], a[212:215], v[144:159]
  s_waitcnt vmcnt(3)
  v_mfma_f32_32x32x16_bf16 v[144:159], v[120:123], a[220:223], v[144:159]
  buffer_load_dwordx4 v3, s[12:15], s93 offen offset:1024 sc1 lds
  v_mfma_f32_32x32x16_bf16 v[160:175], v[204:207], a[160:163], v[160:175]
  v_mfma_f32_32x32x16_bf16 v[160:175], v[236:239], a[168:171], v[160:175]
  buffer_load_dwordx4 v4, s[12:15], s93 offen offset:2048 sc1 lds
  v_mfma_f32_32x32x16_bf16 v[160:175], v[244:247], a[176:179], v[160:175]
  s_nop 6
  ds_write_b64 v7, v[144:145] offset:16384
  ds_write_b64 v7, v[146:147] offset:16896
  v_mfma_f32_32x32x16_bf16 v[160:175], v[252:255], a[184:187], v[160:175]
  buffer_load_dwordx4 v5, s[12:15], s93 offen offset:3072 sc1 lds
  ds_write_b64 v7, v[148:149] offset:17408
  v_mfma_f32_32x32x16_bf16 v[160:175], v[100:103], a[192:195], v[160:175]
  ds_write_b64 v7, v[150:151] offset:17920
  ds_write_b64 v7, v[152:153] offset:18432
  v_mfma_f32_32x32x16_bf16 v[160:175], v[108:111], a[200:203], v[160:175]
  s_add_u32 m0, s56, 0
  s_add_u32 s93, s76, 6424576
  buffer_load_dwordx4 v2, s[12:15], s93 offen offset:0 sc1 lds
  ds_write_b64 v7, v[154:155] offset:18944
  v_mfma_f32_32x32x16_bf16 v[160:175], v[116:119], a[208:211], v[160:175]
  ds_write_b64 v7, v[156:157] offset:19456
  ds_write_b64 v7, v[158:159] offset:19968
  v_mfma_f32_32x32x16_bf16 v[160:175], v[124:127], a[216:219], v[160:175]
  buffer_load_dwordx4 v3, s[12:15], s93 offen offset:1024 sc1 lds
  v_mfma_f32_32x32x16_bf16 v[176:191], v[204:207], a[164:167], v[176:191]
  v_mfma_f32_32x32x16_bf16 v[176:191], v[236:239], a[172:175], v[176:191]
  buffer_load_dwordx4 v4, s[12:15], s93 offen offset:2048 sc1 lds
  v_mfma_f32_32x32x16_bf16 v[176:191], v[244:247], a[180:183], v[176:191]
  s_nop 6
  ds_write_b64 v7, v[160:161] offset:0
  ds_write_b64 v7, v[162:163] offset:512
  v_mfma_f32_32x32x16_bf16 v[176:191], v[252:255], a[188:191], v[176:191]
  buffer_load_dwordx4 v5, s[12:15], s93 offen offset:3072 sc1 lds
  ds_write_b64 v7, v[164:165] offset:1024
  v_mfma_f32_32x32x16_bf16 v[176:191], v[100:103], a[196:199], v[176:191]
  ds_write_b64 v7, v[166:167] offset:1536
  ds_write_b64 v7, v[168:169] offset:2048
  v_mfma_f32_32x32x16_bf16 v[176:191], v[108:111], a[204:207], v[176:191]
  s_add_u32 m0, s56, 16384
  s_add_u32 s93, s76, 6557696
  buffer_load_dwordx4 v2, s[12:15], s93 offen offset:0 sc1 lds
  ds_write_b64 v7, v[170:171] offset:2560
  v_mfma_f32_32x32x16_bf16 v[176:191], v[116:119], a[212:215], v[176:191]
  ds_write_b64 v7, v[172:173] offset:3072
  ds_write_b64 v7, v[174:175] offset:3584
  v_mfma_f32_32x32x16_bf16 v[176:191], v[124:127], a[220:223], v[176:191]
  buffer_load_dwordx4 v3, s[12:15], s93 offen offset:1024 sc1 lds
  v_mfma_f32_32x32x16_bf16 v[128:143], v[200:203], a[160:163], v[128:143]
  v_mfma_f32_32x32x16_bf16 v[128:143], v[232:235], a[168:171], v[128:143]
  buffer_load_dwordx4 v4, s[12:15], s93 offen offset:2048 sc1 lds
  v_mfma_f32_32x32x16_bf16 v[128:143], v[240:243], a[176:179], v[128:143]
  s_nop 6
  ds_write_b64 v7, v[176:177] offset:32768
  ds_write_b64 v7, v[178:179] offset:33280
  v_mfma_f32_32x32x16_bf16 v[128:143], v[248:251], a[184:187], v[128:143]
  buffer_load_dwordx4 v5, s[12:15], s93 offen offset:3072 sc1 lds
  ds_write_b64 v7, v[180:181] offset:33792
  v_mfma_f32_32x32x16_bf16 v[128:143], v[96:99], a[192:195], v[128:143]
  ds_write_b64 v7, v[182:183] offset:34304
  ds_write_b64 v7, v[184:185] offset:34816
  v_mfma_f32_32x32x16_bf16 v[128:143], v[104:107], a[200:203], v[128:143]
  s_add_u32 m0, s56, 49152
  s_add_u32 s93, s76, 6690816
  buffer_load_dwordx4 v2, s[12:15], s93 offen offset:0 sc1 lds
  ds_write_b64 v7, v[186:187] offset:35328
  v_mfma_f32_32x32x16_bf16 v[128:143], v[112:115], a[208:211], v[128:143]
  ds_write_b64 v7, v[188:189] offset:35840
  ds_write_b64 v7, v[190:191] offset:36352
  v_mfma_f32_32x32x16_bf16 v[128:143], v[120:123], a[216:219], v[128:143]
  buffer_load_dwordx4 v3, s[12:15], s93 offen offset:1024 sc1 lds
  s_waitcnt lgkmcnt(0)
  s_barrier
  ds_read_b64 v[144:145], v55 offset:16384
  ds_read_b64 v[146:147], v55 offset:16896
  ds_read_b64 v[148:149], v55 offset:17408
  ds_read_b64 v[150:151], v55 offset:17920
  ds_read_b64 v[152:153], v55 offset:18432
  ds_read_b64 v[154:155], v55 offset:18944
  ds_read_b64 v[156:157], v55 offset:19456
  ds_read_b64 v[158:159], v55 offset:19968
  ds_read_b64 v[160:161], v57 offset:0
  ds_read_b64 v[162:163], v57 offset:512
  ds_read_b64 v[164:165], v57 offset:1024
  ds_read_b64 v[166:167], v57 offset:1536
  ds_read_b64 v[168:169], v57 offset:2048
  ds_read_b64 v[170:171], v57 offset:2560
  ds_read_b64 v[172:173], v57 offset:3072
  ds_read_b64 v[174:175], v57 offset:3584
  ds_read_b64 v[176:177], v59 offset:32768
  ds_read_b64 v[178:179], v59 offset:33280
  ds_read_b64 v[180:181], v59 offset:33792
  ds_read_b64 v[182:183], v59 offset:34304
  ds_read_b64 v[184:185], v59 offset:34816
  ds_read_b64 v[186:187], v59 offset:35328
  ds_read_b64 v[188:189], v59 offset:35840
  ds_read_b64 v[190:191], v59 offset:36352
  v_pk_add_f32 v[128:129], v[128:129], v[208:209]
  v_pk_add_f32 v[130:131], v[130:131], v[210:211]
  v_pk_add_f32 v[132:133], v[132:133], v[212:213]
  v_pk_add_f32 v[134:135], v[134:135], v[214:215]
  v_pk_add_f32 v[136:137], v[136:137], v[216:217]
  v_pk_add_f32 v[138:139], v[138:139], v[218:219]
  v_pk_add_f32 v[140:141], v[140:141], v[220:221]
  v_pk_add_f32 v[142:143], v[142:143], v[222:223]
  s_waitcnt lgkmcnt(15)
  v_pk_add_f32 v[128:129], v[128:129], v[144:145]
  v_pk_add_f32 v[130:131], v[130:131], v[146:147]
  v_pk_add_f32 v[132:133], v[132:133], v[148:149]
  v_pk_add_f32 v[134:135], v[134:135], v[150:151]
  v_pk_add_f32 v[136:137], v[136:137], v[152:153]
  v_pk_add_f32 v[138:139], v[138:139], v[154:155]
  v_pk_add_f32 v[140:141], v[140:141], v[156:157]
  v_pk_add_f32 v[142:143], v[142:143], v[158:159]
  s_waitcnt lgkmcnt(8)
  v_pk_add_f32 v[128:129], v[128:129], v[160:161]
  v_pk_add_f32 v[130:131], v[130:131], v[162:163]
  v_pk_add_f32 v[132:133], v[132:133], v[164:165]
  v_pk_add_f32 v[134:135], v[134:135], v[166:167]
  v_pk_add_f32 v[136:137], v[136:137], v[168:169]
  v_pk_add_f32 v[138:139], v[138:139], v[170:171]
  v_pk_add_f32 v[140:141], v[140:141], v[172:173]
  v_pk_add_f32 v[142:143], v[142:143], v[174:175]
  s_waitcnt lgkmcnt(0)
  v_pk_add_f32 v[128:129], v[128:129], v[176:177]
  v_pk_add_f32 v[130:131], v[130:131], v[178:179]
  v_pk_add_f32 v[132:133], v[132:133], v[180:181]
  v_pk_add_f32 v[134:135], v[134:135], v[182:183]
  v_pk_add_f32 v[136:137], v[136:137], v[184:185]
  v_pk_add_f32 v[138:139], v[138:139], v[186:187]
  v_pk_add_f32 v[140:141], v[140:141], v[188:189]
  v_pk_add_f32 v[142:143], v[142:143], v[190:191]
  s_waitcnt vmcnt(0)
  s_barrier
  ds_read_b64 v[96:97], v8 offset:32768
  ds_read_b64 v[98:99], v8 offset:33792
  ds_read_b64 v[100:101], v8 offset:34816
  ds_read_b64 v[102:103], v8 offset:35840
  ds_read_b64 v[104:105], v8 offset:0
  ds_read_b64 v[106:107], v8 offset:1024
  ds_read_b64 v[108:109], v8 offset:2048
  ds_read_b64 v[110:111], v8 offset:3072
  s_waitcnt lgkmcnt(6)
  v_mfma_f32_32x32x16_bf16 v[128:143], a[0:3], v[96:99], v[128:143]
  ds_read_b64 v[112:113], v8 offset:16384
  ds_read_b64 v[114:115], v8 offset:17408
  s_waitcnt lgkmcnt(6)
  v_mfma_f32_32x32x16_bf16 v[128:143], a[4:7], v[100:103], v[128:143]
  ds_read_b64 v[116:117], v8 offset:18432
  ds_read_b64 v[118:119], v8 offset:19456
  s_waitcnt lgkmcnt(6)
  v_mfma_f32_32x32x16_bf16 v[128:143], a[8:11], v[104:107], v[128:143]
  ds_read_b64 v[120:121], v8 offset:49152
  ds_read_b64 v[122:123], v8 offset:50176
  s_waitcnt lgkmcnt(6)
  v_mfma_f32_32x32x16_bf16 v[128:143], a[12:15], v[108:111], v[128:143]
  ds_read_b64 v[124:125], v8 offset:36864
  ds_read_b64 v[126:127], v8 offset:37888
  s_waitcnt lgkmcnt(6)
  v_mfma_f32_32x32x16_bf16 v[128:143], a[16:19], v[112:115], v[128:143]
  ds_read_b64 v[96:97], v8 offset:38912
  ds_read_b64 v[98:99], v8 offset:39936
  s_waitcnt lgkmcnt(6)
  v_mfma_f32_32x32x16_bf16 v[128:143], a[20:23], v[116:119], v[128:143]
  ds_read_b64 v[100:101], v8 offset:4096
  ds_read_b64 v[102:103], v8 offset:5120
  s_waitcnt lgkmcnt(6)
  v_mfma_f32_32x32x16_bf16 v[128:143], a[24:27], v[120:123], v[128:143]
  ds_read_b64 v[104:105], v8 offset:6144
  ds_read_b64 v[106:107], v8 offset:7168
  s_waitcnt lgkmcnt(6)
  v_mfma_f32_32x32x16_bf16 v[128:143], a[28:31], v[124:127], v[128:143]
  ds_read_b64 v[108:109], v8 offset:20480
  ds_read_b64 v[110:111], v8 offset:21504
  s_waitcnt lgkmcnt(6)
  v_mfma_f32_32x32x16_bf16 v[128:143], a[32:35], v[96:99], v[128:143]
  ds_read_b64 v[112:113], v8 offset:22528
  ds_read_b64 v[114:115], v8 offset:23552
  s_waitcnt lgkmcnt(6)
  v_mfma_f32_32x32x16_bf16 v[128:143], a[36:39], v[100:103], v[128:143]
  ds_read_b64 v[116:117], v8 offset:53248
  ds_read_b64 v[118:119], v8 offset:54272
  s_waitcnt lgkmcnt(6)
  v_mfma_f32_32x32x16_bf16 v[128:143], a[40:43], v[104:107], v[128:143]
  ds_read_b64 v[120:121], v8 offset:40960
  ds_read_b64 v[122:123], v8 offset:41984
  s_waitcnt lgkmcnt(6)
  v_mfma_f32_32x32x16_bf16 v[128:143], a[44:47], v[108:111], v[128:143]
  ds_read_b64 v[124:125], v8 offset:43008
  ds_read_b64 v[126:127], v8 offset:44032
  s_waitcnt lgkmcnt(6)
  v_mfma_f32_32x32x16_bf16 v[128:143], a[48:51], v[112:115], v[128:143]
  ds_read_b64 v[96:97], v8 offset:8192
  ds_read_b64 v[98:99], v8 offset:9216
  s_waitcnt lgkmcnt(6)
  v_mfma_f32_32x32x16_bf16 v[128:143], a[52:55], v[116:119], v[128:143]
  ds_read_b64 v[100:101], v8 offset:10240
  ds_read_b64 v[102:103], v8 offset:11264
  s_waitcnt lgkmcnt(6)
  v_mfma_f32_32x32x16_bf16 v[128:143], a[56:59], v[120:123], v[128:143]
  ds_read_b64 v[104:105], v8 offset:24576
  ds_read_b64 v[106:107], v8 offset:25600
  s_waitcnt lgkmcnt(6)
  v_mfma_f32_32x32x16_bf16 v[128:143], a[60:63], v[124:127], v[128:143]
  ds_read_b64 v[108:109], v8 offset:26624
  ds_read_b64 v[110:111], v8 offset:27648
  s_waitcnt lgkmcnt(6)
  v_mfma_f32_32x32x16_bf16 v[128:143], a[64:67], v[96:99], v[128:143]
  ds_read_b64 v[112:113], v8 offset:57344
  ds_read_b64 v[114:115], v8 offset:58368
  s_waitcnt lgkmcnt(6)
  v_mfma_f32_32x32x16_bf16 v[128:143], a[68:71], v[100:103], v[128:143]
  ds_read_b64 v[116:117], v8 offset:45056
  ds_read_b64 v[118:119], v8 offset:46080
  s_waitcnt lgkmcnt(6)
  v_mfma_f32_32x32x16_bf16 v[128:143], a[72:75], v[104:107], v[128:143]
  ds_read_b64 v[120:121], v8 offset:47104
  ds_read_b64 v[122:123], v8 offset:48128
  s_waitcnt lgkmcnt(6)
  v_mfma_f32_32x32x16_bf16 v[128:143], a[76:79], v[108:111], v[128:143]
  ds_read_b64 v[124:125], v8 offset:12288
  ds_read_b64 v[126:127], v8 offset:13312
  s_waitcnt lgkmcnt(6)
  v_mfma_f32_32x32x16_bf16 v[128:143], a[80:83], v[112:115], v[128:143]
  ds_read_b64_tr_b16 a[96:97], v92 offset:51200
  ds_read_b64_tr_b16 a[98:99], v92 offset:52224
  ds_read_b64 v[96:97], v8 offset:14336
  ds_read_b64 v[98:99], v8 offset:15360
  s_waitcnt lgkmcnt(8)
  v_mfma_f32_32x32x16_bf16 v[128:143], a[84:87], v[116:119], v[128:143]
  ds_read_b64_tr_b16 a[100:101], v92 offset:55296
  ds_read_b64_tr_b16 a[102:103], v92 offset:56320
  ds_read_b64 v[100:101], v8 offset:28672
  ds_read_b64 v[102:103], v8 offset:29696
  s_waitcnt lgkmcnt(10)
  v_mfma_f32_32x32x16_bf16 v[128:143], a[88:91], v[120:123], v[128:143]
  ds_read_b64_tr_b16 a[104:105], v92 offset:59392
  ds_read_b64_tr_b16 a[106:107], v92 offset:60416
  ds_read_b64 v[104:105], v8 offset:30720
  ds_read_b64 v[106:107], v8 offset:31744
  s_waitcnt lgkmcnt(12)
  v_mfma_f32_32x32x16_bf16 v[128:143], a[92:95], v[124:127], v[128:143]
  ds_read_b64_tr_b16 a[108:109], v92 offset:63488
  ds_read_b64_tr_b16 a[110:111], v92 offset:64512
  ds_read_b64 v[108:109], v8 offset:61440
  ds_read_b64 v[110:111], v8 offset:62464
  s_waitcnt lgkmcnt(12)
  v_mfma_f32_32x32x16_bf16 v[128:143], a[96:99], v[96:99], v[128:143]
  s_waitcnt lgkmcnt(8)
  v_mfma_f32_32x32x16_bf16 v[128:143], a[100:103], v[100:103], v[128:143]
  s_waitcnt lgkmcnt(4)
  v_mfma_f32_32x32x16_bf16 v[128:143], a[104:107], v[104:107], v[128:143]
  s_waitcnt lgkmcnt(0)
  v_mfma_f32_32x32x16_bf16 v[128:143], a[108:111], v[108:111], v[128:143]
  s_nop 11
  v_cvt_pk_bf16_f32 v128, v128, v129
  v_cvt_pk_bf16_f32 v129, v130, v131
  v_cvt_pk_bf16_f32 v130, v132, v133
  v_cvt_pk_bf16_f32 v131, v134, v135
  v_cvt_pk_bf16_f32 v132, v136, v137
  v_cvt_pk_bf16_f32 v133, v138, v139
  v_cvt_pk_bf16_f32 v134, v140, v141
  v_cvt_pk_bf16_f32 v135, v142, v143
  v_permlane32_swap_b32 v128, v130
  v_permlane32_swap_b32 v129, v131
  buffer_store_dwordx4 v[128:131], v13, s[44:47], 0 offen offset:0
  v_permlane32_swap_b32 v132, v134
  v_permlane32_swap_b32 v133, v135
  buffer_store_dwordx4 v[132:135], v13, s[44:47], 0 offen offset:32
L_fin:
L_end:
  s_endpgm
L_codeend:
.section .rodata,"a"
.p2align 6
.amdhsa_kernel parallel_sum__sliding_block__geglu_ffn__prompt_kernel
  .amdhsa_next_free_vgpr 512
  .amdhsa_next_free_sgpr 102
  .amdhsa_accum_offset 256
  .amdhsa_group_segment_fixed_size 0
  .amdhsa_kernarg_size 80
  .amdhsa_user_sgpr_count 2
  .amdhsa_user_sgpr_kernarg_segment_ptr 1
  .amdhsa_system_sgpr_workgroup_id_x 1
.end_amdhsa_kernel
```
